```python
import torch

def _softmax(x, axis=-1):
    return torch.softmax(x, dim=axis)
def _gelu(x):
    return torch.nn.functional.gelu(x, approximate="tanh")
def _silu(x):
    return torch.nn.functional.silu(x)
def _sigmoid(x):
    return torch.sigmoid(x)
def _layernorm(x, axis=-1, eps=1e-5):
    m = x.mean(dim=axis, keepdim=True)
    v = x.var(dim=axis, keepdim=True, unbiased=False)
    return (x - m) / torch.sqrt(v + eps)
def _scatter_add(tgt, idx, src, axis=0):
    return tgt.clone().index_add_(axis, idx, src)
def _segment_sum(src, seg, n):
    out = torch.zeros((n,) + src.shape[1:], dtype=src.dtype)
    return out.index_add_(0, seg, src)
def _pad(x, pw):
    flat = tuple(v for pair in reversed(pw) for v in pair)
    return torch.nn.functional.pad(x, flat)

kernel_name = 'parallel_sum__spectral_fnet__moe_arch_mod__prompt'

def setup_inputs():

    _w = (lambda a: (lambda t: t.to(torch.bfloat16) if t.is_floating_point() else t)(torch.as_tensor(a)))
    def _A_setup():
        B, S, D = 1, 2048, 576
        ns = torch.arange(S)[:, None] * torch.arange(S)[None, :]
        nd = torch.arange(D)[:, None] * torch.arange(D)[None, :]
        Ws_re = torch.cos(-2.0 * torch.pi * ns / S).to(float)
        Ws_im = torch.sin(-2.0 * torch.pi * ns / S).to(float)
        Wd_re = torch.cos(-2.0 * torch.pi * nd / D).to(float)
        Wd_im = torch.sin(-2.0 * torch.pi * nd / D).to(float)
        return {
            "x": _w((lambda *s: torch.randn(*s, dtype=torch.bfloat16) * 0.1)(B, S, D)),
            "dft_seq_re": _w(Ws_re),
            "dft_seq_im": _w(Ws_im),
            "dft_hid_re": _w(Wd_re),
            "dft_hid_im": _w(Wd_im),
        }
    _A_in = _A_setup()

    def _B_setup():
        B, S, D, F, C = 1, 2048, 576, 4608, 1
        return {
            "x": _w((lambda *s: torch.randn(*s, dtype=torch.bfloat16) * 0.1)(B, S, D)),
            "w_r": _w((lambda *s: torch.randn(*s, dtype=torch.bfloat16) * 1.6)(D)),
            "w_gate": _w((lambda *s: torch.randn(*s, dtype=torch.bfloat16) * 0.4)(D, F)),
            "w_up": _w((lambda *s: torch.randn(*s, dtype=torch.bfloat16) * 0.4)(D, F)),
            "w_down": _w((lambda *s: torch.randn(*s, dtype=torch.bfloat16) * 0.4)(F, D)),
        }
    _B_in = _B_setup()

    return {
        "A_x": _A_in["x"],
        "A_dft_seq_re": _A_in["dft_seq_re"],
        "A_dft_seq_im": _A_in["dft_seq_im"],
        "A_dft_hid_re": _A_in["dft_hid_re"],
        "A_dft_hid_im": _A_in["dft_hid_im"],
        "B_x": _B_in["x"],
        "B_w_r": _B_in["w_r"],
        "B_w_gate": _B_in["w_gate"],
        "B_w_up": _B_in["w_up"],
        "B_w_down": _B_in["w_down"],
    }

def reference(A_x, A_dft_seq_re, A_dft_seq_im, A_dft_hid_re, A_dft_hid_im, B_x, B_w_r, B_w_gate, B_w_up, B_w_down):
    def _A_ref(x, dft_seq_re, dft_seq_im, dft_hid_re, dft_hid_im):
        a = torch.einsum("bsd,ed->bse", x, dft_hid_re)
        b = torch.einsum("bsd,ed->bse", x, dft_hid_im)
        y = torch.einsum("ts,bse->bte", dft_seq_re, a) - torch.einsum("ts,bse->bte", dft_seq_im, b)
        return y

    def _B_ref(x, w_r, w_gate, w_up, w_down):
        B, S, D = x.shape
        C = 1
        r = x @ w_r
        idx = torch.argsort(-r, axis=-1)[:, :C]
        idx_e = (lambda x, n, axis: torch.repeat_interleave(x, n, dim=axis))(idx.reshape(B, C, 1), D, axis=2)
        x_sel = (lambda x, i, axis: torch.take_along_dim(x, i, dim=axis))(x, idx_e, axis=1)
        g = _silu(x_sel @ w_gate)
        u = x_sel @ w_up
        y = (g * u) @ w_down
        r_sel = _sigmoid((lambda x, i, axis: torch.take_along_dim(x, i, dim=axis))(r, idx, axis=1))
        y = y * r_sel.reshape(B, C, 1)
        b_off = (torch.arange(B) * S).reshape(B, 1)
        flat_idx = (idx + b_off).reshape(B * C)
        zero = (x * 0.0).reshape(B * S, D)
        upd = _scatter_add(zero, flat_idx, y.reshape(B * C, D), axis=0)
        return x + upd.reshape(B, S, D)

    x = A_x
    xn = _layernorm(x, axis=-1)
    return x + _A_ref(xn, A_dft_seq_re, A_dft_seq_im, A_dft_hid_re, A_dft_hid_im) + _B_ref(xn, B_w_r, B_w_gate, B_w_up, B_w_down)
```

```asm
; @launch kernel=k1_kernel grid=(448,1,1) block=(256,1,1) lds=59968
; @launch kernel=k2_kernel grid=(288,1,1) block=(256,1,1) lds=9216
.amdgcn_target "amdgcn-amd-amdhsa--gfx950"
.text
.globl k1_kernel
.p2align 8
.type k1_kernel,@function
k1_kernel:
    s_cmp_ge_u32 s2, 256
    s_cbranch_scc1 k1_aux
    s_load_dwordx2 s[4:5], s[0:1], 0
    s_load_dwordx2 s[6:7], s[0:1], 48
    s_load_dwordx2 s[42:43], s[0:1], 88
    s_load_dwordx2 s[8:9], s[0:1], 96
    s_setprio 3
    s_waitcnt lgkmcnt(0)
    s_mov_b32 s12, s4
    s_mov_b32 s13, s5
    s_mov_b32 s14, 2359296
    s_mov_b32 s15, 0x00020000
    s_mov_b32 s16, s6
    s_mov_b32 s17, s7
    s_mov_b32 s18, 1152
    s_mov_b32 s19, 0x00020000
    s_mov_b32 s20, s8
    s_mov_b32 s21, s9
    s_mov_b32 s22, 4194304
    s_mov_b32 s23, 0x00020000
    s_lshr_b32 s29, s2, 3
    s_mul_i32 s31, s29, 43
    s_lshr_b32 s31, s31, 7
    s_mul_i32 s30, s31, 3
    s_sub_u32 s25, s29, s30
    s_sub_u32 s30, s29, 24
    s_cmp_ge_u32 s29, 24
    s_cselect_b32 s31, s30, s31
    s_cselect_b32 s25, 3, s25
    s_and_b32 s30, s2, 7
    s_lshl_b32 s30, s30, 3
    s_add_u32 s24, s30, s31
    s_and_b32 s26, s25, 1
    s_lshr_b32 s27, s25, 1
    v_lshrrev_b32 v5, 6, v0
    s_nop 0
    v_readfirstlane_b32 s28, v5
    v_and_b32 v5, 63, v0
    v_and_b32 v204, 7, v5
    v_lshrrev_b32 v205, 3, v5
    s_lshl_b32 s29, s28, 9
    s_add_u32 s29, s29, s24
    v_lshlrev_b32 v206, 6, v204
    v_add_u32 v206, s29, v206
    s_movk_i32 s29, 1152
    v_mul_lo_u32 v207, v206, s29
    v_lshlrev_b32 v208, 4, v205
    v_add_u32 v1, v207, v208
    v_sub_u32 v2, v207, v208
    v_add_u32 v2, 304, v2
    v_cmp_gt_u32 vcc, 2, v205
    v_mov_b32 v209, 0x7ff00000
    s_nop 0
    v_cndmask_b32 v3, v209, v1, vcc
    v_cndmask_b32 v4, v209, v2, vcc
    s_cmp_eq_u32 s25, 3
    s_cbranch_scc0 k1_now
    s_mul_i32 s29, s28, 1152
    s_add_u32 s29, s29, 55360
    s_mov_b32 m0, s29
    v_lshlrev_b32 v210, 4, v5
    buffer_load_dwordx4 v210, s[16:19], 0 offen lds
    s_mov_b64 exec, 0xff
    buffer_load_dwordx4 v210, s[16:19], 0 offen offset:1024 lds
    s_mov_b64 exec, -1
    v_add_u32 v211, s29, v208
    v_sub_u32 v212, 112, v208
    v_add_u32 v212, s29, v212
k1_now:
    s_mul_i32 s29, s28, 9216
    s_add_u32 s29, s29, 18496
    s_add_u32 m0, s29, 0
    s_nop 0
    buffer_load_dwordx4 v1, s[12:15], 0 offen offset:0 lds
    s_add_u32 m0, s29, 7168
    s_nop 0
    buffer_load_dwordx4 v1, s[12:15], 0 offen offset:1024 lds
    s_add_u32 m0, s29, 3584
    s_nop 0
    buffer_load_dwordx4 v1, s[12:15], 0 offen offset:512 lds
    s_add_u32 m0, s29, 2688
    s_nop 0
    buffer_load_dwordx4 v1, s[12:15], 0 offen offset:384 lds
    s_add_u32 m0, s29, 4480
    s_nop 0
    buffer_load_dwordx4 v1, s[12:15], 0 offen offset:640 lds
    s_add_u32 m0, s29, 896
    s_nop 0
    buffer_load_dwordx4 v1, s[12:15], 0 offen offset:128 lds
    s_add_u32 m0, s29, 6272
    s_nop 0
    buffer_load_dwordx4 v1, s[12:15], 0 offen offset:896 lds
    s_add_u32 m0, s29, 1792
    s_nop 0
    buffer_load_dwordx4 v1, s[12:15], 0 offen offset:256 lds
    s_add_u32 m0, s29, 5376
    s_nop 0
    buffer_load_dwordx4 v1, s[12:15], 0 offen offset:768 lds
    v_lshlrev_b32 v3, 4, v204
    v_add_u32 v3, s29, v3
    v_lshlrev_b32 v4, 7, v205
    v_sub_u32 v2, 896, v4
    v_add_u32 v2, v2, v3
    v_add_u32 v3, v4, v3
    v_mov_b32 v40, 0
    v_mov_b32 v41, 0
    v_mov_b32 v42, 0
    v_mov_b32 v43, 0
    v_mov_b32 v44, 0
    v_mov_b32 v45, 0
    v_mov_b32 v46, 0
    v_mov_b32 v47, 0
    v_mov_b32 v48, 0
    v_mov_b32 v49, 0
    v_mov_b32 v50, 0
    v_mov_b32 v51, 0
    v_mov_b32 v52, 0
    v_mov_b32 v53, 0
    v_mov_b32 v54, 0
    v_mov_b32 v55, 0
    v_and_b32 v213, 15, v5
    v_lshrrev_b32 v214, 4, v5
    v_cvt_f32_u32 v238, v214
    v_mov_b32 v239, 0x3e6471c7
    v_mov_b32 v241, 0x3be38e39
    v_fmac_f32 v239, v238, v241
    v_mov_b32 v241, 0x3c638e39
    v_mov_b32 v242, 0x3a638e39
    v_fma_f32 v238, v238, v241, v242
    s_mul_i32 s32, s27, 5
    s_add_u32 s32, s32, s28
    s_movk_i32 s33, 4
    s_lshl_b32 s29, s32, 5
    s_add_u32 s29, s29, s26
    s_add_u32 s29, s29, 1
    v_lshlrev_b32 v232, 1, v213
    v_add_u32 v232, s29, v232
    v_cvt_f32_u32 v232, v232
    v_mul_f32 v234, 0x3ae38e39, v232
    v_mul_f32 v233, 0x3a638e39, v232
    v_cos_f32 v236, v234
    v_cos_f32 v200, v233
    v_sin_f32 v201, v233
    v_mul_f32 v240, 0x3d638e39, v232
    v_add_f32 v236, v236, v236
    v_mul_f32 v241, v232, v238
    v_mov_b32 v233, v241
    v_cos_f32 v216, v233
    v_sin_f32 v217, v233
    v_add_f32 v233, v233, v234
    v_cos_f32 v218, v233
    v_sin_f32 v219, v233
    s_nop 0
    v_pk_fma_f32 v[220:221], v[236:237], v[218:219], v[216:217] op_sel_hi:[0,1,1] neg_lo:[0,0,1] neg_hi:[0,0,1]
    v_pk_fma_f32 v[222:223], v[236:237], v[220:221], v[218:219] op_sel_hi:[0,1,1] neg_lo:[0,0,1] neg_hi:[0,0,1]
    v_pk_fma_f32 v[224:225], v[236:237], v[222:223], v[220:221] op_sel_hi:[0,1,1] neg_lo:[0,0,1] neg_hi:[0,0,1]
    v_pk_fma_f32 v[226:227], v[236:237], v[224:225], v[222:223] op_sel_hi:[0,1,1] neg_lo:[0,0,1] neg_hi:[0,0,1]
    v_pk_fma_f32 v[228:229], v[236:237], v[226:227], v[224:225] op_sel_hi:[0,1,1] neg_lo:[0,0,1] neg_hi:[0,0,1]
    v_pk_fma_f32 v[230:231], v[236:237], v[228:229], v[226:227] op_sel_hi:[0,1,1] neg_lo:[0,0,1] neg_hi:[0,0,1]
    v_cvt_pk_bf16_f32 v104, v216, v218
    v_cvt_pk_bf16_f32 v122, v217, v219
    v_cvt_pk_bf16_f32 v105, v220, v222
    v_cvt_pk_bf16_f32 v123, v221, v223
    v_cvt_pk_bf16_f32 v106, v224, v226
    v_cvt_pk_bf16_f32 v124, v225, v227
    v_cvt_pk_bf16_f32 v107, v228, v230
    v_cvt_pk_bf16_f32 v125, v229, v231
    v_add_f32 v241, v241, v240
    v_mov_b32 v233, v241
    v_cos_f32 v216, v233
    v_sin_f32 v217, v233
    v_add_f32 v233, v233, v234
    v_cos_f32 v218, v233
    v_sin_f32 v219, v233
    s_nop 0
    v_pk_fma_f32 v[220:221], v[236:237], v[218:219], v[216:217] op_sel_hi:[0,1,1] neg_lo:[0,0,1] neg_hi:[0,0,1]
    v_pk_fma_f32 v[222:223], v[236:237], v[220:221], v[218:219] op_sel_hi:[0,1,1] neg_lo:[0,0,1] neg_hi:[0,0,1]
    v_pk_fma_f32 v[224:225], v[236:237], v[222:223], v[220:221] op_sel_hi:[0,1,1] neg_lo:[0,0,1] neg_hi:[0,0,1]
    v_pk_fma_f32 v[226:227], v[236:237], v[224:225], v[222:223] op_sel_hi:[0,1,1] neg_lo:[0,0,1] neg_hi:[0,0,1]
    v_pk_fma_f32 v[228:229], v[236:237], v[226:227], v[224:225] op_sel_hi:[0,1,1] neg_lo:[0,0,1] neg_hi:[0,0,1]
    v_pk_fma_f32 v[230:231], v[236:237], v[228:229], v[226:227] op_sel_hi:[0,1,1] neg_lo:[0,0,1] neg_hi:[0,0,1]
    v_cvt_pk_bf16_f32 v108, v216, v218
    v_cvt_pk_bf16_f32 v126, v217, v219
    v_cvt_pk_bf16_f32 v109, v220, v222
    v_cvt_pk_bf16_f32 v127, v221, v223
    v_cvt_pk_bf16_f32 v110, v224, v226
    v_cvt_pk_bf16_f32 v128, v225, v227
    v_cvt_pk_bf16_f32 v111, v228, v230
    v_cvt_pk_bf16_f32 v129, v229, v231
    v_add_f32 v241, v241, v240
    v_mov_b32 v233, v241
    v_cos_f32 v216, v233
    v_sin_f32 v217, v233
    v_add_f32 v233, v233, v234
    v_cos_f32 v218, v233
    v_sin_f32 v219, v233
    s_nop 0
    v_pk_fma_f32 v[220:221], v[236:237], v[218:219], v[216:217] op_sel_hi:[0,1,1] neg_lo:[0,0,1] neg_hi:[0,0,1]
    v_pk_fma_f32 v[222:223], v[236:237], v[220:221], v[218:219] op_sel_hi:[0,1,1] neg_lo:[0,0,1] neg_hi:[0,0,1]
    v_pk_fma_f32 v[224:225], v[236:237], v[222:223], v[220:221] op_sel_hi:[0,1,1] neg_lo:[0,0,1] neg_hi:[0,0,1]
    v_pk_fma_f32 v[226:227], v[236:237], v[224:225], v[222:223] op_sel_hi:[0,1,1] neg_lo:[0,0,1] neg_hi:[0,0,1]
    v_pk_fma_f32 v[228:229], v[236:237], v[226:227], v[224:225] op_sel_hi:[0,1,1] neg_lo:[0,0,1] neg_hi:[0,0,1]
    v_pk_fma_f32 v[230:231], v[236:237], v[228:229], v[226:227] op_sel_hi:[0,1,1] neg_lo:[0,0,1] neg_hi:[0,0,1]
    v_cvt_pk_bf16_f32 v112, v216, v218
    v_cvt_pk_bf16_f32 v130, v217, v219
    v_cvt_pk_bf16_f32 v113, v220, v222
    v_cvt_pk_bf16_f32 v131, v221, v223
    v_cvt_pk_bf16_f32 v114, v224, v226
    v_cvt_pk_bf16_f32 v132, v225, v227
    v_cvt_pk_bf16_f32 v115, v228, v230
    v_cvt_pk_bf16_f32 v133, v229, v231
    v_add_f32 v241, v241, v240
    v_mov_b32 v233, v241
    v_cos_f32 v216, v233
    v_sin_f32 v217, v233
    v_add_f32 v233, v233, v234
    v_cos_f32 v218, v233
    v_sin_f32 v219, v233
    s_nop 0
    v_pk_fma_f32 v[220:221], v[236:237], v[218:219], v[216:217] op_sel_hi:[0,1,1] neg_lo:[0,0,1] neg_hi:[0,0,1]
    v_pk_fma_f32 v[222:223], v[236:237], v[220:221], v[218:219] op_sel_hi:[0,1,1] neg_lo:[0,0,1] neg_hi:[0,0,1]
    v_pk_fma_f32 v[224:225], v[236:237], v[222:223], v[220:221] op_sel_hi:[0,1,1] neg_lo:[0,0,1] neg_hi:[0,0,1]
    v_pk_fma_f32 v[226:227], v[236:237], v[224:225], v[222:223] op_sel_hi:[0,1,1] neg_lo:[0,0,1] neg_hi:[0,0,1]
    v_pk_fma_f32 v[228:229], v[236:237], v[226:227], v[224:225] op_sel_hi:[0,1,1] neg_lo:[0,0,1] neg_hi:[0,0,1]
    v_pk_fma_f32 v[230:231], v[236:237], v[228:229], v[226:227] op_sel_hi:[0,1,1] neg_lo:[0,0,1] neg_hi:[0,0,1]
    v_cvt_pk_bf16_f32 v116, v216, v218
    v_cvt_pk_bf16_f32 v134, v217, v219
    v_cvt_pk_bf16_f32 v117, v220, v222
    v_cvt_pk_bf16_f32 v135, v221, v223
    v_cvt_pk_bf16_f32 v118, v224, v226
    v_cvt_pk_bf16_f32 v136, v225, v227
    v_cvt_pk_bf16_f32 v119, v228, v230
    v_cvt_pk_bf16_f32 v137, v229, v231
    v_mul_f32 v233, v232, v239
    v_cos_f32 v216, v233
    v_sin_f32 v217, v233
    v_add_f32 v233, v233, v234
    v_cos_f32 v218, v233
    v_sin_f32 v219, v233
    s_nop 0
    v_pk_fma_f32 v[220:221], v[236:237], v[218:219], v[216:217] op_sel_hi:[0,1,1] neg_lo:[0,0,1] neg_hi:[0,0,1]
    v_pk_fma_f32 v[222:223], v[236:237], v[220:221], v[218:219] op_sel_hi:[0,1,1] neg_lo:[0,0,1] neg_hi:[0,0,1]
    v_cvt_pk_bf16_f32 v120, v216, v218
    v_cvt_pk_bf16_f32 v138, v217, v219
    v_cvt_pk_bf16_f32 v121, v220, v222
    v_cvt_pk_bf16_f32 v139, v221, v223
    s_lshl_b32 s34, s27, 2
    s_or_b32 s34, s34, s28
    s_cmp_eq_u32 s34, 0
    s_cbranch_scc0 k1_no2
    s_lshl_b32 s29, s33, 5
    s_add_u32 s29, s29, s26
    s_add_u32 s29, s29, 1
    v_lshlrev_b32 v232, 1, v213
    v_add_u32 v232, s29, v232
    v_cvt_f32_u32 v232, v232
    v_mul_f32 v234, 0x3ae38e39, v232
    v_mul_f32 v233, 0x3a638e39, v232
    v_cos_f32 v236, v234
    v_cos_f32 v202, v233
    v_sin_f32 v203, v233
    v_mul_f32 v240, 0x3d638e39, v232
    v_add_f32 v236, v236, v236
    v_mul_f32 v241, v232, v238
    v_mov_b32 v233, v241
    v_cos_f32 v216, v233
    v_sin_f32 v217, v233
    v_add_f32 v233, v233, v234
    v_cos_f32 v218, v233
    v_sin_f32 v219, v233
    s_nop 0
    v_pk_fma_f32 v[220:221], v[236:237], v[218:219], v[216:217] op_sel_hi:[0,1,1] neg_lo:[0,0,1] neg_hi:[0,0,1]
    v_pk_fma_f32 v[222:223], v[236:237], v[220:221], v[218:219] op_sel_hi:[0,1,1] neg_lo:[0,0,1] neg_hi:[0,0,1]
    v_pk_fma_f32 v[224:225], v[236:237], v[222:223], v[220:221] op_sel_hi:[0,1,1] neg_lo:[0,0,1] neg_hi:[0,0,1]
    v_pk_fma_f32 v[226:227], v[236:237], v[224:225], v[222:223] op_sel_hi:[0,1,1] neg_lo:[0,0,1] neg_hi:[0,0,1]
    v_pk_fma_f32 v[228:229], v[236:237], v[226:227], v[224:225] op_sel_hi:[0,1,1] neg_lo:[0,0,1] neg_hi:[0,0,1]
    v_pk_fma_f32 v[230:231], v[236:237], v[228:229], v[226:227] op_sel_hi:[0,1,1] neg_lo:[0,0,1] neg_hi:[0,0,1]
    v_cvt_pk_bf16_f32 v140, v216, v218
    v_cvt_pk_bf16_f32 v158, v217, v219
    v_cvt_pk_bf16_f32 v141, v220, v222
    v_cvt_pk_bf16_f32 v159, v221, v223
    v_cvt_pk_bf16_f32 v142, v224, v226
    v_cvt_pk_bf16_f32 v160, v225, v227
    v_cvt_pk_bf16_f32 v143, v228, v230
    v_cvt_pk_bf16_f32 v161, v229, v231
    v_add_f32 v241, v241, v240
    v_mov_b32 v233, v241
    v_cos_f32 v216, v233
    v_sin_f32 v217, v233
    v_add_f32 v233, v233, v234
    v_cos_f32 v218, v233
    v_sin_f32 v219, v233
    s_nop 0
    v_pk_fma_f32 v[220:221], v[236:237], v[218:219], v[216:217] op_sel_hi:[0,1,1] neg_lo:[0,0,1] neg_hi:[0,0,1]
    v_pk_fma_f32 v[222:223], v[236:237], v[220:221], v[218:219] op_sel_hi:[0,1,1] neg_lo:[0,0,1] neg_hi:[0,0,1]
    v_pk_fma_f32 v[224:225], v[236:237], v[222:223], v[220:221] op_sel_hi:[0,1,1] neg_lo:[0,0,1] neg_hi:[0,0,1]
    v_pk_fma_f32 v[226:227], v[236:237], v[224:225], v[222:223] op_sel_hi:[0,1,1] neg_lo:[0,0,1] neg_hi:[0,0,1]
    v_pk_fma_f32 v[228:229], v[236:237], v[226:227], v[224:225] op_sel_hi:[0,1,1] neg_lo:[0,0,1] neg_hi:[0,0,1]
    v_pk_fma_f32 v[230:231], v[236:237], v[228:229], v[226:227] op_sel_hi:[0,1,1] neg_lo:[0,0,1] neg_hi:[0,0,1]
    v_cvt_pk_bf16_f32 v144, v216, v218
    v_cvt_pk_bf16_f32 v162, v217, v219
    v_cvt_pk_bf16_f32 v145, v220, v222
    v_cvt_pk_bf16_f32 v163, v221, v223
    v_cvt_pk_bf16_f32 v146, v224, v226
    v_cvt_pk_bf16_f32 v164, v225, v227
    v_cvt_pk_bf16_f32 v147, v228, v230
    v_cvt_pk_bf16_f32 v165, v229, v231
    v_add_f32 v241, v241, v240
    v_mov_b32 v233, v241
    v_cos_f32 v216, v233
    v_sin_f32 v217, v233
    v_add_f32 v233, v233, v234
    v_cos_f32 v218, v233
    v_sin_f32 v219, v233
    s_nop 0
    v_pk_fma_f32 v[220:221], v[236:237], v[218:219], v[216:217] op_sel_hi:[0,1,1] neg_lo:[0,0,1] neg_hi:[0,0,1]
    v_pk_fma_f32 v[222:223], v[236:237], v[220:221], v[218:219] op_sel_hi:[0,1,1] neg_lo:[0,0,1] neg_hi:[0,0,1]
    v_pk_fma_f32 v[224:225], v[236:237], v[222:223], v[220:221] op_sel_hi:[0,1,1] neg_lo:[0,0,1] neg_hi:[0,0,1]
    v_pk_fma_f32 v[226:227], v[236:237], v[224:225], v[222:223] op_sel_hi:[0,1,1] neg_lo:[0,0,1] neg_hi:[0,0,1]
    v_pk_fma_f32 v[228:229], v[236:237], v[226:227], v[224:225] op_sel_hi:[0,1,1] neg_lo:[0,0,1] neg_hi:[0,0,1]
    v_pk_fma_f32 v[230:231], v[236:237], v[228:229], v[226:227] op_sel_hi:[0,1,1] neg_lo:[0,0,1] neg_hi:[0,0,1]
    v_cvt_pk_bf16_f32 v148, v216, v218
    v_cvt_pk_bf16_f32 v166, v217, v219
    v_cvt_pk_bf16_f32 v149, v220, v222
    v_cvt_pk_bf16_f32 v167, v221, v223
    v_cvt_pk_bf16_f32 v150, v224, v226
    v_cvt_pk_bf16_f32 v168, v225, v227
    v_cvt_pk_bf16_f32 v151, v228, v230
    v_cvt_pk_bf16_f32 v169, v229, v231
    v_add_f32 v241, v241, v240
    v_mov_b32 v233, v241
    v_cos_f32 v216, v233
    v_sin_f32 v217, v233
    v_add_f32 v233, v233, v234
    v_cos_f32 v218, v233
    v_sin_f32 v219, v233
    s_nop 0
    v_pk_fma_f32 v[220:221], v[236:237], v[218:219], v[216:217] op_sel_hi:[0,1,1] neg_lo:[0,0,1] neg_hi:[0,0,1]
    v_pk_fma_f32 v[222:223], v[236:237], v[220:221], v[218:219] op_sel_hi:[0,1,1] neg_lo:[0,0,1] neg_hi:[0,0,1]
    v_pk_fma_f32 v[224:225], v[236:237], v[222:223], v[220:221] op_sel_hi:[0,1,1] neg_lo:[0,0,1] neg_hi:[0,0,1]
    v_pk_fma_f32 v[226:227], v[236:237], v[224:225], v[222:223] op_sel_hi:[0,1,1] neg_lo:[0,0,1] neg_hi:[0,0,1]
    v_pk_fma_f32 v[228:229], v[236:237], v[226:227], v[224:225] op_sel_hi:[0,1,1] neg_lo:[0,0,1] neg_hi:[0,0,1]
    v_pk_fma_f32 v[230:231], v[236:237], v[228:229], v[226:227] op_sel_hi:[0,1,1] neg_lo:[0,0,1] neg_hi:[0,0,1]
    v_cvt_pk_bf16_f32 v152, v216, v218
    v_cvt_pk_bf16_f32 v170, v217, v219
    v_cvt_pk_bf16_f32 v153, v220, v222
    v_cvt_pk_bf16_f32 v171, v221, v223
    v_cvt_pk_bf16_f32 v154, v224, v226
    v_cvt_pk_bf16_f32 v172, v225, v227
    v_cvt_pk_bf16_f32 v155, v228, v230
    v_cvt_pk_bf16_f32 v173, v229, v231
    v_mul_f32 v233, v232, v239
    v_cos_f32 v216, v233
    v_sin_f32 v217, v233
    v_add_f32 v233, v233, v234
    v_cos_f32 v218, v233
    v_sin_f32 v219, v233
    s_nop 0
    v_pk_fma_f32 v[220:221], v[236:237], v[218:219], v[216:217] op_sel_hi:[0,1,1] neg_lo:[0,0,1] neg_hi:[0,0,1]
    v_pk_fma_f32 v[222:223], v[236:237], v[220:221], v[218:219] op_sel_hi:[0,1,1] neg_lo:[0,0,1] neg_hi:[0,0,1]
    v_cvt_pk_bf16_f32 v156, v216, v218
    v_cvt_pk_bf16_f32 v174, v217, v219
    v_cvt_pk_bf16_f32 v157, v220, v222
    v_cvt_pk_bf16_f32 v175, v221, v223
k1_no2:
    v_and_b32 v243, 1, v213
    v_mul_u32_u24 v243, 0x8000, v243
    v_lshlrev_b32 v244, 16, v243
    v_or_b32 v243, v243, v244
    v_mov_b32 v244, 0x80008000
    v_lshlrev_b32 v245, 8, v214
    v_add_u32 v245, s24, v245
    v_cvt_f32_u32 v245, v245
    v_mul_f32 v245, 0x3a000000, v245
    v_add_u32 v232, 0, v213
    v_cvt_f32_u32 v232, v232
    v_mul_f32 v234, 0x3d000000, v232
    v_mul_f32 v233, v232, v245
    v_cos_f32 v236, v234
    s_nop 0
    v_add_f32 v236, v236, v236
    v_cos_f32 v216, v233
    v_sin_f32 v217, v233
    v_add_f32 v233, v233, v234
    v_cos_f32 v218, v233
    v_sin_f32 v219, v233
    s_nop 0
    v_pk_fma_f32 v[220:221], v[236:237], v[218:219], v[216:217] op_sel_hi:[0,1,1] neg_lo:[0,0,1] neg_hi:[0,0,1]
    v_pk_fma_f32 v[222:223], v[236:237], v[220:221], v[218:219] op_sel_hi:[0,1,1] neg_lo:[0,0,1] neg_hi:[0,0,1]
    v_cvt_pk_bf16_f32 v176, v216, v218
    v_cvt_pk_bf16_f32 v180, v217, v219
    v_cvt_pk_bf16_f32 v177, v220, v222
    v_cvt_pk_bf16_f32 v181, v221, v223
    v_xor_b32 v178, v176, v243
    v_xor_b32 v179, v177, v243
    v_xor_b32 v182, v180, v243
    v_xor_b32 v183, v181, v243
    v_xor_b32 v184, v180, v244
    v_xor_b32 v185, v181, v244
    v_xor_b32 v186, v182, v244
    v_xor_b32 v187, v183, v244
    v_add_u32 v232, 16, v213
    v_cvt_f32_u32 v232, v232
    v_mul_f32 v234, 0x3d000000, v232
    v_mul_f32 v233, v232, v245
    v_cos_f32 v236, v234
    s_nop 0
    v_add_f32 v236, v236, v236
    v_cos_f32 v216, v233
    v_sin_f32 v217, v233
    v_add_f32 v233, v233, v234
    v_cos_f32 v218, v233
    v_sin_f32 v219, v233
    s_nop 0
    v_pk_fma_f32 v[220:221], v[236:237], v[218:219], v[216:217] op_sel_hi:[0,1,1] neg_lo:[0,0,1] neg_hi:[0,0,1]
    v_pk_fma_f32 v[222:223], v[236:237], v[220:221], v[218:219] op_sel_hi:[0,1,1] neg_lo:[0,0,1] neg_hi:[0,0,1]
    v_cvt_pk_bf16_f32 v188, v216, v218
    v_cvt_pk_bf16_f32 v192, v217, v219
    v_cvt_pk_bf16_f32 v189, v220, v222
    v_cvt_pk_bf16_f32 v193, v221, v223
    v_xor_b32 v190, v188, v243
    v_xor_b32 v191, v189, v243
    v_xor_b32 v194, v192, v243
    v_xor_b32 v195, v193, v243
    v_xor_b32 v196, v192, v244
    v_xor_b32 v197, v193, v244
    v_xor_b32 v198, v194, v244
    v_xor_b32 v199, v195, v244
    s_lshr_b32 s29, s28, 1
    s_mul_i32 s29, s29, 4608
    s_and_b32 s30, s28, 1
    s_lshl_b32 s30, s30, 3
    v_add_u32 v248, s30, v204
    v_lshrrev_b32 v249, 2, v205
    v_lshlrev_b32 v249, 10, v249
    v_and_b32 v250, 3, v205
    v_lshlrev_b32 v250, 8, v250
    v_add_u32 v249, v249, v250
    v_lshlrev_b32 v250, 4, v248
    v_add3_u32 v246, v249, v250, s29
    v_lshlrev_b32 v249, 8, v205
    v_lshlrev_b32 v250, 3, v248
    v_add3_u32 v247, v249, v250, s29
    v_mov_b32 v216, 0
    v_mov_b32 v217, 0
    v_mov_b32 v218, 0
    v_mov_b32 v219, 0
    s_mov_b32 s35, 0x3f803f80
    s_cmp_eq_u32 s25, 3
    s_cbranch_scc1 k1_st3
    s_waitcnt vmcnt(4)
    ds_read_b128 v[8:11], v3 offset:0
    ds_read_b128 v[12:15], v2 offset:8192
    ds_read_b128 v[16:19], v2 offset:3584
    ds_read_b128 v[20:23], v3 offset:4608
    s_waitcnt lgkmcnt(0)
    v_dot2_f32_bf16 v216, v8, s35, v216
    v_dot2_f32_bf16 v217, v8, v8, v217
    v_dot2_f32_bf16 v216, v9, s35, v216
    v_dot2_f32_bf16 v217, v9, v9, v217
    v_dot2_f32_bf16 v216, v10, s35, v216
    v_dot2_f32_bf16 v217, v10, v10, v217
    v_dot2_f32_bf16 v216, v11, s35, v216
    v_dot2_f32_bf16 v217, v11, v11, v217
    v_dot2_f32_bf16 v216, v12, s35, v216
    v_dot2_f32_bf16 v217, v12, v12, v217
    v_dot2_f32_bf16 v216, v13, s35, v216
    v_dot2_f32_bf16 v217, v13, v13, v217
    v_dot2_f32_bf16 v216, v14, s35, v216
    v_dot2_f32_bf16 v217, v14, v14, v217
    v_dot2_f32_bf16 v216, v15, s35, v216
    v_dot2_f32_bf16 v217, v15, v15, v217
    v_dot2_f32_bf16 v216, v16, s35, v216
    v_dot2_f32_bf16 v217, v16, v16, v217
    v_dot2_f32_bf16 v216, v17, s35, v216
    v_dot2_f32_bf16 v217, v17, v17, v217
    v_dot2_f32_bf16 v216, v18, s35, v216
    v_dot2_f32_bf16 v217, v18, v18, v217
    v_dot2_f32_bf16 v216, v19, s35, v216
    v_dot2_f32_bf16 v217, v19, v19, v217
    v_dot2_f32_bf16 v216, v20, s35, v216
    v_dot2_f32_bf16 v217, v20, v20, v217
    v_dot2_f32_bf16 v216, v21, s35, v216
    v_dot2_f32_bf16 v217, v21, v21, v217
    v_dot2_f32_bf16 v216, v22, s35, v216
    v_dot2_f32_bf16 v217, v22, v22, v217
    v_dot2_f32_bf16 v216, v23, s35, v216
    v_dot2_f32_bf16 v217, v23, v23, v217
    s_waitcnt vmcnt(0)
    ds_read_b128 v[24:27], v3 offset:1024
    ds_read_b128 v[28:31], v2 offset:7168
    ds_read_b128 v[32:35], v2 offset:2560
    ds_read_b128 v[36:39], v3 offset:5632
    s_mov_b64 exec, 0xffff
    ds_read_b128 v[40:43], v3 offset:2048
    ds_read_b128 v[44:47], v2 offset:6144
    ds_read_b128 v[48:51], v2 offset:1536
    ds_read_b128 v[52:55], v3 offset:6656
    s_mov_b64 exec, -1
    s_waitcnt lgkmcnt(0)
    v_dot2_f32_bf16 v216, v24, s35, v216
    v_dot2_f32_bf16 v217, v24, v24, v217
    v_dot2_f32_bf16 v216, v25, s35, v216
    v_dot2_f32_bf16 v217, v25, v25, v217
    v_dot2_f32_bf16 v216, v26, s35, v216
    v_dot2_f32_bf16 v217, v26, v26, v217
    v_dot2_f32_bf16 v216, v27, s35, v216
    v_dot2_f32_bf16 v217, v27, v27, v217
    v_dot2_f32_bf16 v216, v28, s35, v216
    v_dot2_f32_bf16 v217, v28, v28, v217
    v_dot2_f32_bf16 v216, v29, s35, v216
    v_dot2_f32_bf16 v217, v29, v29, v217
    v_dot2_f32_bf16 v216, v30, s35, v216
    v_dot2_f32_bf16 v217, v30, v30, v217
    v_dot2_f32_bf16 v216, v31, s35, v216
    v_dot2_f32_bf16 v217, v31, v31, v217
    v_dot2_f32_bf16 v216, v32, s35, v216
    v_dot2_f32_bf16 v217, v32, v32, v217
    v_dot2_f32_bf16 v216, v33, s35, v216
    v_dot2_f32_bf16 v217, v33, v33, v217
    v_dot2_f32_bf16 v216, v34, s35, v216
    v_dot2_f32_bf16 v217, v34, v34, v217
    v_dot2_f32_bf16 v216, v35, s35, v216
    v_dot2_f32_bf16 v217, v35, v35, v217
    v_dot2_f32_bf16 v216, v36, s35, v216
    v_dot2_f32_bf16 v217, v36, v36, v217
    v_dot2_f32_bf16 v216, v37, s35, v216
    v_dot2_f32_bf16 v217, v37, v37, v217
    v_dot2_f32_bf16 v216, v38, s35, v216
    v_dot2_f32_bf16 v217, v38, v38, v217
    v_dot2_f32_bf16 v216, v39, s35, v216
    v_dot2_f32_bf16 v217, v39, v39, v217
    v_dot2_f32_bf16 v216, v40, s35, v216
    v_dot2_f32_bf16 v217, v40, v40, v217
    v_dot2_f32_bf16 v216, v41, s35, v216
    v_dot2_f32_bf16 v217, v41, v41, v217
    v_dot2_f32_bf16 v216, v42, s35, v216
    v_dot2_f32_bf16 v217, v42, v42, v217
    v_dot2_f32_bf16 v216, v43, s35, v216
    v_dot2_f32_bf16 v217, v43, v43, v217
    v_dot2_f32_bf16 v216, v44, s35, v216
    v_dot2_f32_bf16 v217, v44, v44, v217
    v_dot2_f32_bf16 v216, v45, s35, v216
    v_dot2_f32_bf16 v217, v45, v45, v217
    v_dot2_f32_bf16 v216, v46, s35, v216
    v_dot2_f32_bf16 v217, v46, v46, v217
    v_dot2_f32_bf16 v216, v47, s35, v216
    v_dot2_f32_bf16 v217, v47, v47, v217
    v_dot2_f32_bf16 v216, v48, s35, v216
    v_dot2_f32_bf16 v217, v48, v48, v217
    v_dot2_f32_bf16 v216, v49, s35, v216
    v_dot2_f32_bf16 v217, v49, v49, v217
    v_dot2_f32_bf16 v216, v50, s35, v216
    v_dot2_f32_bf16 v217, v50, v50, v217
    v_dot2_f32_bf16 v216, v51, s35, v216
    v_dot2_f32_bf16 v217, v51, v51, v217
    v_dot2_f32_bf16 v216, v52, s35, v216
    v_dot2_f32_bf16 v217, v52, v52, v217
    v_dot2_f32_bf16 v216, v53, s35, v216
    v_dot2_f32_bf16 v217, v53, v53, v217
    v_dot2_f32_bf16 v216, v54, s35, v216
    v_dot2_f32_bf16 v217, v54, v54, v217
    v_dot2_f32_bf16 v216, v55, s35, v216
    v_dot2_f32_bf16 v217, v55, v55, v217
    s_branch k1_st
k1_st3:
    s_waitcnt vmcnt(9)
    v_mov_b32 v88, 0
    v_mov_b32 v89, 0
    v_mov_b32 v90, 0
    v_mov_b32 v91, 0
    v_mov_b32 v92, 0
    v_mov_b32 v93, 0
    v_mov_b32 v94, 0
    v_mov_b32 v95, 0
    v_mov_b32 v96, 0
    v_mov_b32 v97, 0
    v_mov_b32 v98, 0
    v_mov_b32 v99, 0
    v_mov_b32 v100, 0
    v_mov_b32 v101, 0
    v_mov_b32 v102, 0
    v_mov_b32 v103, 0
    ds_read_b128 v[56:59], v211 offset:0
    ds_read_b128 v[60:63], v212 offset:1024
    ds_read_b128 v[64:67], v212 offset:448
    ds_read_b128 v[68:71], v211 offset:576
    ds_read_b128 v[72:75], v211 offset:128
    ds_read_b128 v[76:79], v212 offset:896
    ds_read_b128 v[80:83], v212 offset:320
    ds_read_b128 v[84:87], v211 offset:704
    s_mov_b64 exec, 0xffff
    ds_read_b128 v[88:91], v211 offset:256
    ds_read_b128 v[92:95], v212 offset:768
    ds_read_b128 v[96:99], v212 offset:192
    ds_read_b128 v[100:103], v211 offset:832
    s_mov_b64 exec, -1
    s_waitcnt lgkmcnt(0)
    v_dot2_f32_bf16 v219, v56, s35, v219
    v_dot2_f32_bf16 v219, v57, s35, v219
    v_dot2_f32_bf16 v219, v58, s35, v219
    v_dot2_f32_bf16 v219, v59, s35, v219
    v_dot2_f32_bf16 v219, v60, s35, v219
    v_dot2_f32_bf16 v219, v61, s35, v219
    v_dot2_f32_bf16 v219, v62, s35, v219
    v_dot2_f32_bf16 v219, v63, s35, v219
    v_dot2_f32_bf16 v219, v64, s35, v219
    v_dot2_f32_bf16 v219, v65, s35, v219
    v_dot2_f32_bf16 v219, v66, s35, v219
    v_dot2_f32_bf16 v219, v67, s35, v219
    v_dot2_f32_bf16 v219, v68, s35, v219
    v_dot2_f32_bf16 v219, v69, s35, v219
    v_dot2_f32_bf16 v219, v70, s35, v219
    v_dot2_f32_bf16 v219, v71, s35, v219
    v_dot2_f32_bf16 v219, v72, s35, v219
    v_dot2_f32_bf16 v219, v73, s35, v219
    v_dot2_f32_bf16 v219, v74, s35, v219
    v_dot2_f32_bf16 v219, v75, s35, v219
    v_dot2_f32_bf16 v219, v76, s35, v219
    v_dot2_f32_bf16 v219, v77, s35, v219
    v_dot2_f32_bf16 v219, v78, s35, v219
    v_dot2_f32_bf16 v219, v79, s35, v219
    v_dot2_f32_bf16 v219, v80, s35, v219
    v_dot2_f32_bf16 v219, v81, s35, v219
    v_dot2_f32_bf16 v219, v82, s35, v219
    v_dot2_f32_bf16 v219, v83, s35, v219
    v_dot2_f32_bf16 v219, v84, s35, v219
    v_dot2_f32_bf16 v219, v85, s35, v219
    v_dot2_f32_bf16 v219, v86, s35, v219
    v_dot2_f32_bf16 v219, v87, s35, v219
    v_dot2_f32_bf16 v219, v88, s35, v219
    v_dot2_f32_bf16 v219, v89, s35, v219
    v_dot2_f32_bf16 v219, v90, s35, v219
    v_dot2_f32_bf16 v219, v91, s35, v219
    v_dot2_f32_bf16 v219, v92, s35, v219
    v_dot2_f32_bf16 v219, v93, s35, v219
    v_dot2_f32_bf16 v219, v94, s35, v219
    v_dot2_f32_bf16 v219, v95, s35, v219
    v_dot2_f32_bf16 v219, v96, s35, v219
    v_dot2_f32_bf16 v219, v97, s35, v219
    v_dot2_f32_bf16 v219, v98, s35, v219
    v_dot2_f32_bf16 v219, v99, s35, v219
    v_dot2_f32_bf16 v219, v100, s35, v219
    v_dot2_f32_bf16 v219, v101, s35, v219
    v_dot2_f32_bf16 v219, v102, s35, v219
    v_dot2_f32_bf16 v219, v103, s35, v219
    s_waitcnt vmcnt(4)
    ds_read_b128 v[8:11], v3 offset:0
    ds_read_b128 v[12:15], v2 offset:8192
    ds_read_b128 v[16:19], v2 offset:3584
    ds_read_b128 v[20:23], v3 offset:4608
    s_waitcnt lgkmcnt(0)
    v_dot2_f32_bf16 v218, v8, v56, v218
    v_dot2_f32_bf16 v216, v8, s35, v216
    v_dot2_f32_bf16 v217, v8, v8, v217
    v_dot2_f32_bf16 v218, v9, v57, v218
    v_dot2_f32_bf16 v216, v9, s35, v216
    v_dot2_f32_bf16 v217, v9, v9, v217
    v_dot2_f32_bf16 v218, v10, v58, v218
    v_dot2_f32_bf16 v216, v10, s35, v216
    v_dot2_f32_bf16 v217, v10, v10, v217
    v_dot2_f32_bf16 v218, v11, v59, v218
    v_dot2_f32_bf16 v216, v11, s35, v216
    v_dot2_f32_bf16 v217, v11, v11, v217
    v_dot2_f32_bf16 v218, v12, v60, v218
    v_dot2_f32_bf16 v216, v12, s35, v216
    v_dot2_f32_bf16 v217, v12, v12, v217
    v_dot2_f32_bf16 v218, v13, v61, v218
    v_dot2_f32_bf16 v216, v13, s35, v216
    v_dot2_f32_bf16 v217, v13, v13, v217
    v_dot2_f32_bf16 v218, v14, v62, v218
    v_dot2_f32_bf16 v216, v14, s35, v216
    v_dot2_f32_bf16 v217, v14, v14, v217
    v_dot2_f32_bf16 v218, v15, v63, v218
    v_dot2_f32_bf16 v216, v15, s35, v216
    v_dot2_f32_bf16 v217, v15, v15, v217
    v_dot2_f32_bf16 v218, v16, v64, v218
    v_dot2_f32_bf16 v216, v16, s35, v216
    v_dot2_f32_bf16 v217, v16, v16, v217
    v_dot2_f32_bf16 v218, v17, v65, v218
    v_dot2_f32_bf16 v216, v17, s35, v216
    v_dot2_f32_bf16 v217, v17, v17, v217
    v_dot2_f32_bf16 v218, v18, v66, v218
    v_dot2_f32_bf16 v216, v18, s35, v216
    v_dot2_f32_bf16 v217, v18, v18, v217
    v_dot2_f32_bf16 v218, v19, v67, v218
    v_dot2_f32_bf16 v216, v19, s35, v216
    v_dot2_f32_bf16 v217, v19, v19, v217
    v_dot2_f32_bf16 v218, v20, v68, v218
    v_dot2_f32_bf16 v216, v20, s35, v216
    v_dot2_f32_bf16 v217, v20, v20, v217
    v_dot2_f32_bf16 v218, v21, v69, v218
    v_dot2_f32_bf16 v216, v21, s35, v216
    v_dot2_f32_bf16 v217, v21, v21, v217
    v_dot2_f32_bf16 v218, v22, v70, v218
    v_dot2_f32_bf16 v216, v22, s35, v216
    v_dot2_f32_bf16 v217, v22, v22, v217
    v_dot2_f32_bf16 v218, v23, v71, v218
    v_dot2_f32_bf16 v216, v23, s35, v216
    v_dot2_f32_bf16 v217, v23, v23, v217
    s_waitcnt vmcnt(0)
    ds_read_b128 v[24:27], v3 offset:1024
    ds_read_b128 v[28:31], v2 offset:7168
    ds_read_b128 v[32:35], v2 offset:2560
    ds_read_b128 v[36:39], v3 offset:5632
    s_mov_b64 exec, 0xffff
    ds_read_b128 v[40:43], v3 offset:2048
    ds_read_b128 v[44:47], v2 offset:6144
    ds_read_b128 v[48:51], v2 offset:1536
    ds_read_b128 v[52:55], v3 offset:6656
    s_mov_b64 exec, -1
    s_waitcnt lgkmcnt(0)
    v_dot2_f32_bf16 v218, v24, v72, v218
    v_dot2_f32_bf16 v216, v24, s35, v216
    v_dot2_f32_bf16 v217, v24, v24, v217
    v_dot2_f32_bf16 v218, v25, v73, v218
    v_dot2_f32_bf16 v216, v25, s35, v216
    v_dot2_f32_bf16 v217, v25, v25, v217
    v_dot2_f32_bf16 v218, v26, v74, v218
    v_dot2_f32_bf16 v216, v26, s35, v216
    v_dot2_f32_bf16 v217, v26, v26, v217
    v_dot2_f32_bf16 v218, v27, v75, v218
    v_dot2_f32_bf16 v216, v27, s35, v216
    v_dot2_f32_bf16 v217, v27, v27, v217
    v_dot2_f32_bf16 v218, v28, v76, v218
    v_dot2_f32_bf16 v216, v28, s35, v216
    v_dot2_f32_bf16 v217, v28, v28, v217
    v_dot2_f32_bf16 v218, v29, v77, v218
    v_dot2_f32_bf16 v216, v29, s35, v216
    v_dot2_f32_bf16 v217, v29, v29, v217
    v_dot2_f32_bf16 v218, v30, v78, v218
    v_dot2_f32_bf16 v216, v30, s35, v216
    v_dot2_f32_bf16 v217, v30, v30, v217
    v_dot2_f32_bf16 v218, v31, v79, v218
    v_dot2_f32_bf16 v216, v31, s35, v216
    v_dot2_f32_bf16 v217, v31, v31, v217
    v_dot2_f32_bf16 v218, v32, v80, v218
    v_dot2_f32_bf16 v216, v32, s35, v216
    v_dot2_f32_bf16 v217, v32, v32, v217
    v_dot2_f32_bf16 v218, v33, v81, v218
    v_dot2_f32_bf16 v216, v33, s35, v216
    v_dot2_f32_bf16 v217, v33, v33, v217
    v_dot2_f32_bf16 v218, v34, v82, v218
    v_dot2_f32_bf16 v216, v34, s35, v216
    v_dot2_f32_bf16 v217, v34, v34, v217
    v_dot2_f32_bf16 v218, v35, v83, v218
    v_dot2_f32_bf16 v216, v35, s35, v216
    v_dot2_f32_bf16 v217, v35, v35, v217
    v_dot2_f32_bf16 v218, v36, v84, v218
    v_dot2_f32_bf16 v216, v36, s35, v216
    v_dot2_f32_bf16 v217, v36, v36, v217
    v_dot2_f32_bf16 v218, v37, v85, v218
    v_dot2_f32_bf16 v216, v37, s35, v216
    v_dot2_f32_bf16 v217, v37, v37, v217
    v_dot2_f32_bf16 v218, v38, v86, v218
    v_dot2_f32_bf16 v216, v38, s35, v216
    v_dot2_f32_bf16 v217, v38, v38, v217
    v_dot2_f32_bf16 v218, v39, v87, v218
    v_dot2_f32_bf16 v216, v39, s35, v216
    v_dot2_f32_bf16 v217, v39, v39, v217
    v_dot2_f32_bf16 v218, v40, v88, v218
    v_dot2_f32_bf16 v216, v40, s35, v216
    v_dot2_f32_bf16 v217, v40, v40, v217
    v_dot2_f32_bf16 v218, v41, v89, v218
    v_dot2_f32_bf16 v216, v41, s35, v216
    v_dot2_f32_bf16 v217, v41, v41, v217
    v_dot2_f32_bf16 v218, v42, v90, v218
    v_dot2_f32_bf16 v216, v42, s35, v216
    v_dot2_f32_bf16 v217, v42, v42, v217
    v_dot2_f32_bf16 v218, v43, v91, v218
    v_dot2_f32_bf16 v216, v43, s35, v216
    v_dot2_f32_bf16 v217, v43, v43, v217
    v_dot2_f32_bf16 v218, v44, v92, v218
    v_dot2_f32_bf16 v216, v44, s35, v216
    v_dot2_f32_bf16 v217, v44, v44, v217
    v_dot2_f32_bf16 v218, v45, v93, v218
    v_dot2_f32_bf16 v216, v45, s35, v216
    v_dot2_f32_bf16 v217, v45, v45, v217
    v_dot2_f32_bf16 v218, v46, v94, v218
    v_dot2_f32_bf16 v216, v46, s35, v216
    v_dot2_f32_bf16 v217, v46, v46, v217
    v_dot2_f32_bf16 v218, v47, v95, v218
    v_dot2_f32_bf16 v216, v47, s35, v216
    v_dot2_f32_bf16 v217, v47, v47, v217
    v_dot2_f32_bf16 v218, v48, v96, v218
    v_dot2_f32_bf16 v216, v48, s35, v216
    v_dot2_f32_bf16 v217, v48, v48, v217
    v_dot2_f32_bf16 v218, v49, v97, v218
    v_dot2_f32_bf16 v216, v49, s35, v216
    v_dot2_f32_bf16 v217, v49, v49, v217
    v_dot2_f32_bf16 v218, v50, v98, v218
    v_dot2_f32_bf16 v216, v50, s35, v216
    v_dot2_f32_bf16 v217, v50, v50, v217
    v_dot2_f32_bf16 v218, v51, v99, v218
    v_dot2_f32_bf16 v216, v51, s35, v216
    v_dot2_f32_bf16 v217, v51, v51, v217
    v_dot2_f32_bf16 v218, v52, v100, v218
    v_dot2_f32_bf16 v216, v52, s35, v216
    v_dot2_f32_bf16 v217, v52, v52, v217
    v_dot2_f32_bf16 v218, v53, v101, v218
    v_dot2_f32_bf16 v216, v53, s35, v216
    v_dot2_f32_bf16 v217, v53, v53, v217
    v_dot2_f32_bf16 v218, v54, v102, v218
    v_dot2_f32_bf16 v216, v54, s35, v216
    v_dot2_f32_bf16 v217, v54, v54, v217
    v_dot2_f32_bf16 v218, v55, v103, v218
    v_dot2_f32_bf16 v216, v55, s35, v216
    v_dot2_f32_bf16 v217, v55, v55, v217
k1_st:
    s_nop 1
    v_add_f32 v216, v216, v216 row_ror:8 row_mask:0xf bank_mask:0xf
    v_add_f32 v217, v217, v217 row_ror:8 row_mask:0xf bank_mask:0xf
    v_add_f32 v218, v218, v218 row_ror:8 row_mask:0xf bank_mask:0xf
    v_add_f32 v219, v219, v219 row_ror:8 row_mask:0xf bank_mask:0xf
    v_mov_b32 v220, v216
    v_mov_b32 v221, v217
    v_mov_b32 v222, v218
    v_mov_b32 v223, v219
    v_permlane16_swap_b32 v216, v220
    v_permlane16_swap_b32 v217, v221
    v_permlane16_swap_b32 v218, v222
    v_permlane16_swap_b32 v219, v223
    v_add_f32 v216, v216, v220
    v_add_f32 v217, v217, v221
    v_add_f32 v218, v218, v222
    v_add_f32 v219, v219, v223
    v_mov_b32 v220, v216
    v_mov_b32 v221, v217
    v_mov_b32 v222, v218
    v_mov_b32 v223, v219
    v_permlane32_swap_b32 v216, v220
    v_permlane32_swap_b32 v217, v221
    v_permlane32_swap_b32 v218, v222
    v_permlane32_swap_b32 v219, v223
    v_add_f32 v216, v216, v220
    v_add_f32 v217, v217, v221
    v_add_f32 v218, v218, v222
    v_add_f32 v219, v219, v223
    v_mul_f32 v224, 0x3ae38e39, v216
    v_mul_f32 v217, 0x3ae38e39, v217
    v_fma_f32 v217, -v224, v224, v217
    v_max_f32 v217, 0, v217
    v_add_f32 v217, 0x3727c5ac, v217
    v_rsq_f32 v226, v217
    s_cmp_eq_u32 s26, 1
    s_cselect_b32 s29, 1.0, -1.0
    s_cselect_b32 s30, -4.0, 0
    v_mul_f32 v227, s29, v226
    v_mul_f32 v228, v224, v226
    v_mul_f32 v228, s30, v228
    s_cmp_eq_u32 s25, 3
    s_cbranch_scc0 k1_nost
    v_fma_f32 v218, -v224, v219, v218
    v_mul_f32 v218, v218, v226
    v_mov_b32 v220, v224
    v_mov_b32 v221, v226
    v_mov_b32 v222, v218
    v_mov_b32 v223, 0
    v_and_b32 v230, 31, v206
    v_lshrrev_b32 v225, 5, v206
    v_lshl_add_u32 v230, v230, 6, v225
    v_lshlrev_b32 v230, 3, v230
    v_add_u32 v230, 2359296, v230
    v_ashrrev_i32 v231, 31, v218
    v_or_b32 v231, 0x80000000, v231
    v_xor_b32 v231, v231, v218
    v_and_b32 v231, 0xfffff800, v231
    v_sub_u32 v225, 2047, v206
    v_or_b32 v231, v231, v225
    s_nop 1
    v_max_u32 v231, v231, v231 quad_perm:[1,0,3,2] row_mask:0xf bank_mask:0xf
    s_nop 1
    v_max_u32 v231, v231, v231 quad_perm:[2,3,0,1] row_mask:0xf bank_mask:0xf
    s_nop 1
    v_max_u32 v231, v231, v231 row_half_mirror row_mask:0xf bank_mask:0xf
    s_lshl_b32 s29, s28, 2
    v_mov_b32 v225, s29
    ds_write_b32 v225, v231 offset:18432
    s_mov_b64 s[36:37], exec
    s_mov_b64 exec, 0xff
    buffer_store_dwordx2 v[220:221], v230, s[20:23], 0 offen
    s_mov_b64 exec, s[36:37]
    s_waitcnt lgkmcnt(0)
    s_barrier
    s_cmp_eq_u32 s28, 0
    s_cbranch_scc0 k1_nost
    v_mov_b32 v252, 0
    ds_read_b128 v[248:251], v252 offset:18432
    s_mov_b32 s44, s42
    s_mov_b32 s45, s43
    s_mov_b32 s46, 256
    s_mov_b32 s47, 0x00020000
    s_lshl_b32 s29, s24, 2
    v_mov_b32 v252, s29
    s_waitcnt lgkmcnt(0)
    v_max_u32 v248, v248, v249
    v_max_u32 v250, v250, v251
    v_max_u32 v248, v248, v250
    s_mov_b64 exec, 1
    buffer_store_dword v248, v252, s[44:47], 0 offen sc1
    s_mov_b64 exec, s[36:37]
k1_nost:
    v_lshlrev_b32 v56, 16, v8
    v_and_b32 v57, 0xffff0000, v8
    v_and_b32 v64, 0xffff0000, v15
    v_lshlrev_b32 v65, 16, v15
    v_and_b32 v72, 0xffff0000, v19
    v_lshlrev_b32 v73, 16, v19
    v_lshlrev_b32 v80, 16, v20
    v_and_b32 v81, 0xffff0000, v20
    v_lshlrev_b32 v58, 16, v9
    v_and_b32 v59, 0xffff0000, v9
    v_and_b32 v66, 0xffff0000, v14
    v_lshlrev_b32 v67, 16, v14
    v_and_b32 v74, 0xffff0000, v18
    v_lshlrev_b32 v75, 16, v18
    v_lshlrev_b32 v82, 16, v21
    v_and_b32 v83, 0xffff0000, v21
    v_lshlrev_b32 v60, 16, v10
    v_and_b32 v61, 0xffff0000, v10
    v_and_b32 v68, 0xffff0000, v13
    v_lshlrev_b32 v69, 16, v13
    v_and_b32 v76, 0xffff0000, v17
    v_lshlrev_b32 v77, 16, v17
    v_lshlrev_b32 v84, 16, v22
    v_and_b32 v85, 0xffff0000, v22
    v_lshlrev_b32 v62, 16, v11
    v_and_b32 v63, 0xffff0000, v11
    v_and_b32 v70, 0xffff0000, v12
    v_lshlrev_b32 v71, 16, v12
    v_and_b32 v78, 0xffff0000, v16
    v_lshlrev_b32 v79, 16, v16
    v_lshlrev_b32 v86, 16, v23
    v_and_b32 v87, 0xffff0000, v23
    v_pk_add_f32 v[96:97], v[56:57], v[64:65]
    v_pk_add_f32 v[56:57], v[56:57], v[64:65] neg_lo:[0,1] neg_hi:[0,1]
    v_pk_add_f32 v[98:99], v[80:81], v[72:73]
    v_pk_add_f32 v[80:81], v[80:81], v[72:73] neg_lo:[0,1] neg_hi:[0,1]
    v_pk_fma_f32 v[98:99], v[98:99], v[226:227], v[228:229] op_sel:[0,1,0] op_sel_hi:[1,1,0]
    v_pk_mul_f32 v[80:81], v[80:81], v[226:227] op_sel:[0,1] op_sel_hi:[1,1]
    v_pk_fma_f32 v[96:97], v[96:97], v[226:227], v[98:99] op_sel_hi:[1,0,1]
    v_pk_fma_f32 v[56:57], v[56:57], v[226:227], v[80:81] op_sel_hi:[1,0,1]
    v_cvt_pk_bf16_f32 v88, v96, v97
    v_cvt_pk_bf16_f32 v92, v56, v57
    v_pk_add_f32 v[96:97], v[58:59], v[66:67]
    v_pk_add_f32 v[58:59], v[58:59], v[66:67] neg_lo:[0,1] neg_hi:[0,1]
    v_pk_add_f32 v[98:99], v[82:83], v[74:75]
    v_pk_add_f32 v[82:83], v[82:83], v[74:75] neg_lo:[0,1] neg_hi:[0,1]
    v_pk_fma_f32 v[98:99], v[98:99], v[226:227], v[228:229] op_sel:[0,1,0] op_sel_hi:[1,1,0]
    v_pk_mul_f32 v[82:83], v[82:83], v[226:227] op_sel:[0,1] op_sel_hi:[1,1]
    v_pk_fma_f32 v[96:97], v[96:97], v[226:227], v[98:99] op_sel_hi:[1,0,1]
    v_pk_fma_f32 v[58:59], v[58:59], v[226:227], v[82:83] op_sel_hi:[1,0,1]
    v_cvt_pk_bf16_f32 v89, v96, v97
    v_cvt_pk_bf16_f32 v93, v58, v59
    v_pk_add_f32 v[96:97], v[60:61], v[68:69]
    v_pk_add_f32 v[60:61], v[60:61], v[68:69] neg_lo:[0,1] neg_hi:[0,1]
    v_pk_add_f32 v[98:99], v[84:85], v[76:77]
    v_pk_add_f32 v[84:85], v[84:85], v[76:77] neg_lo:[0,1] neg_hi:[0,1]
    v_pk_fma_f32 v[98:99], v[98:99], v[226:227], v[228:229] op_sel:[0,1,0] op_sel_hi:[1,1,0]
    v_pk_mul_f32 v[84:85], v[84:85], v[226:227] op_sel:[0,1] op_sel_hi:[1,1]
    v_pk_fma_f32 v[96:97], v[96:97], v[226:227], v[98:99] op_sel_hi:[1,0,1]
    v_pk_fma_f32 v[60:61], v[60:61], v[226:227], v[84:85] op_sel_hi:[1,0,1]
    v_cvt_pk_bf16_f32 v90, v96, v97
    v_cvt_pk_bf16_f32 v94, v60, v61
    v_pk_add_f32 v[96:97], v[62:63], v[70:71]
    v_pk_add_f32 v[62:63], v[62:63], v[70:71] neg_lo:[0,1] neg_hi:[0,1]
    v_pk_add_f32 v[98:99], v[86:87], v[78:79]
    v_pk_add_f32 v[86:87], v[86:87], v[78:79] neg_lo:[0,1] neg_hi:[0,1]
    v_pk_fma_f32 v[98:99], v[98:99], v[226:227], v[228:229] op_sel:[0,1,0] op_sel_hi:[1,1,0]
    v_pk_mul_f32 v[86:87], v[86:87], v[226:227] op_sel:[0,1] op_sel_hi:[1,1]
    v_pk_fma_f32 v[96:97], v[96:97], v[226:227], v[98:99] op_sel_hi:[1,0,1]
    v_pk_fma_f32 v[62:63], v[62:63], v[226:227], v[86:87] op_sel_hi:[1,0,1]
    v_cvt_pk_bf16_f32 v91, v96, v97
    v_cvt_pk_bf16_f32 v95, v62, v63
    ds_write_b128 v246, v[88:91] offset:0
    ds_write_b128 v246, v[92:95] offset:9216
    v_lshlrev_b32 v56, 16, v24
    v_and_b32 v57, 0xffff0000, v24
    v_and_b32 v64, 0xffff0000, v31
    v_lshlrev_b32 v65, 16, v31
    v_and_b32 v72, 0xffff0000, v35
    v_lshlrev_b32 v73, 16, v35
    v_lshlrev_b32 v80, 16, v36
    v_and_b32 v81, 0xffff0000, v36
    v_lshlrev_b32 v58, 16, v25
    v_and_b32 v59, 0xffff0000, v25
    v_and_b32 v66, 0xffff0000, v30
    v_lshlrev_b32 v67, 16, v30
    v_and_b32 v74, 0xffff0000, v34
    v_lshlrev_b32 v75, 16, v34
    v_lshlrev_b32 v82, 16, v37
    v_and_b32 v83, 0xffff0000, v37
    v_lshlrev_b32 v60, 16, v26
    v_and_b32 v61, 0xffff0000, v26
    v_and_b32 v68, 0xffff0000, v29
    v_lshlrev_b32 v69, 16, v29
    v_and_b32 v76, 0xffff0000, v33
    v_lshlrev_b32 v77, 16, v33
    v_lshlrev_b32 v84, 16, v38
    v_and_b32 v85, 0xffff0000, v38
    v_lshlrev_b32 v62, 16, v27
    v_and_b32 v63, 0xffff0000, v27
    v_and_b32 v70, 0xffff0000, v28
    v_lshlrev_b32 v71, 16, v28
    v_and_b32 v78, 0xffff0000, v32
    v_lshlrev_b32 v79, 16, v32
    v_lshlrev_b32 v86, 16, v39
    v_and_b32 v87, 0xffff0000, v39
    v_pk_add_f32 v[96:97], v[56:57], v[64:65]
    v_pk_add_f32 v[56:57], v[56:57], v[64:65] neg_lo:[0,1] neg_hi:[0,1]
    v_pk_add_f32 v[98:99], v[80:81], v[72:73]
    v_pk_add_f32 v[80:81], v[80:81], v[72:73] neg_lo:[0,1] neg_hi:[0,1]
    v_pk_fma_f32 v[98:99], v[98:99], v[226:227], v[228:229] op_sel:[0,1,0] op_sel_hi:[1,1,0]
    v_pk_mul_f32 v[80:81], v[80:81], v[226:227] op_sel:[0,1] op_sel_hi:[1,1]
    v_pk_fma_f32 v[96:97], v[96:97], v[226:227], v[98:99] op_sel_hi:[1,0,1]
    v_pk_fma_f32 v[56:57], v[56:57], v[226:227], v[80:81] op_sel_hi:[1,0,1]
    v_cvt_pk_bf16_f32 v88, v96, v97
    v_cvt_pk_bf16_f32 v92, v56, v57
    v_pk_add_f32 v[96:97], v[58:59], v[66:67]
    v_pk_add_f32 v[58:59], v[58:59], v[66:67] neg_lo:[0,1] neg_hi:[0,1]
    v_pk_add_f32 v[98:99], v[82:83], v[74:75]
    v_pk_add_f32 v[82:83], v[82:83], v[74:75] neg_lo:[0,1] neg_hi:[0,1]
    v_pk_fma_f32 v[98:99], v[98:99], v[226:227], v[228:229] op_sel:[0,1,0] op_sel_hi:[1,1,0]
    v_pk_mul_f32 v[82:83], v[82:83], v[226:227] op_sel:[0,1] op_sel_hi:[1,1]
    v_pk_fma_f32 v[96:97], v[96:97], v[226:227], v[98:99] op_sel_hi:[1,0,1]
    v_pk_fma_f32 v[58:59], v[58:59], v[226:227], v[82:83] op_sel_hi:[1,0,1]
    v_cvt_pk_bf16_f32 v89, v96, v97
    v_cvt_pk_bf16_f32 v93, v58, v59
    v_pk_add_f32 v[96:97], v[60:61], v[68:69]
    v_pk_add_f32 v[60:61], v[60:61], v[68:69] neg_lo:[0,1] neg_hi:[0,1]
    v_pk_add_f32 v[98:99], v[84:85], v[76:77]
    v_pk_add_f32 v[84:85], v[84:85], v[76:77] neg_lo:[0,1] neg_hi:[0,1]
    v_pk_fma_f32 v[98:99], v[98:99], v[226:227], v[228:229] op_sel:[0,1,0] op_sel_hi:[1,1,0]
    v_pk_mul_f32 v[84:85], v[84:85], v[226:227] op_sel:[0,1] op_sel_hi:[1,1]
    v_pk_fma_f32 v[96:97], v[96:97], v[226:227], v[98:99] op_sel_hi:[1,0,1]
    v_pk_fma_f32 v[60:61], v[60:61], v[226:227], v[84:85] op_sel_hi:[1,0,1]
    v_cvt_pk_bf16_f32 v90, v96, v97
    v_cvt_pk_bf16_f32 v94, v60, v61
    v_pk_add_f32 v[96:97], v[62:63], v[70:71]
    v_pk_add_f32 v[62:63], v[62:63], v[70:71] neg_lo:[0,1] neg_hi:[0,1]
    v_pk_add_f32 v[98:99], v[86:87], v[78:79]
    v_pk_add_f32 v[86:87], v[86:87], v[78:79] neg_lo:[0,1] neg_hi:[0,1]
    v_pk_fma_f32 v[98:99], v[98:99], v[226:227], v[228:229] op_sel:[0,1,0] op_sel_hi:[1,1,0]
    v_pk_mul_f32 v[86:87], v[86:87], v[226:227] op_sel:[0,1] op_sel_hi:[1,1]
    v_pk_fma_f32 v[96:97], v[96:97], v[226:227], v[98:99] op_sel_hi:[1,0,1]
    v_pk_fma_f32 v[62:63], v[62:63], v[226:227], v[86:87] op_sel_hi:[1,0,1]
    v_cvt_pk_bf16_f32 v91, v96, v97
    v_cvt_pk_bf16_f32 v95, v62, v63
    ds_write_b128 v246, v[88:91] offset:2048
    ds_write_b128 v246, v[92:95] offset:11264
    v_lshlrev_b32 v56, 16, v40
    v_and_b32 v57, 0xffff0000, v40
    v_and_b32 v64, 0xffff0000, v47
    v_lshlrev_b32 v65, 16, v47
    v_and_b32 v72, 0xffff0000, v51
    v_lshlrev_b32 v73, 16, v51
    v_lshlrev_b32 v80, 16, v52
    v_and_b32 v81, 0xffff0000, v52
    v_lshlrev_b32 v58, 16, v41
    v_and_b32 v59, 0xffff0000, v41
    v_and_b32 v66, 0xffff0000, v46
    v_lshlrev_b32 v67, 16, v46
    v_and_b32 v74, 0xffff0000, v50
    v_lshlrev_b32 v75, 16, v50
    v_lshlrev_b32 v82, 16, v53
    v_and_b32 v83, 0xffff0000, v53
    v_lshlrev_b32 v60, 16, v42
    v_and_b32 v61, 0xffff0000, v42
    v_and_b32 v68, 0xffff0000, v45
    v_lshlrev_b32 v69, 16, v45
    v_and_b32 v76, 0xffff0000, v49
    v_lshlrev_b32 v77, 16, v49
    v_lshlrev_b32 v84, 16, v54
    v_and_b32 v85, 0xffff0000, v54
    v_lshlrev_b32 v62, 16, v43
    v_and_b32 v63, 0xffff0000, v43
    v_and_b32 v70, 0xffff0000, v44
    v_lshlrev_b32 v71, 16, v44
    v_and_b32 v78, 0xffff0000, v48
    v_lshlrev_b32 v79, 16, v48
    v_lshlrev_b32 v86, 16, v55
    v_and_b32 v87, 0xffff0000, v55
    v_pk_add_f32 v[96:97], v[56:57], v[64:65]
    v_pk_add_f32 v[56:57], v[56:57], v[64:65] neg_lo:[0,1] neg_hi:[0,1]
    v_pk_add_f32 v[98:99], v[80:81], v[72:73]
    v_pk_add_f32 v[80:81], v[80:81], v[72:73] neg_lo:[0,1] neg_hi:[0,1]
    v_pk_fma_f32 v[98:99], v[98:99], v[226:227], v[228:229] op_sel:[0,1,0] op_sel_hi:[1,1,0]
    v_pk_mul_f32 v[80:81], v[80:81], v[226:227] op_sel:[0,1] op_sel_hi:[1,1]
    v_pk_fma_f32 v[96:97], v[96:97], v[226:227], v[98:99] op_sel_hi:[1,0,1]
    v_pk_fma_f32 v[56:57], v[56:57], v[226:227], v[80:81] op_sel_hi:[1,0,1]
    v_cvt_pk_bf16_f32 v88, v96, v97
    v_cvt_pk_bf16_f32 v92, v56, v57
    v_pk_add_f32 v[96:97], v[58:59], v[66:67]
    v_pk_add_f32 v[58:59], v[58:59], v[66:67] neg_lo:[0,1] neg_hi:[0,1]
    v_pk_add_f32 v[98:99], v[82:83], v[74:75]
    v_pk_add_f32 v[82:83], v[82:83], v[74:75] neg_lo:[0,1] neg_hi:[0,1]
    v_pk_fma_f32 v[98:99], v[98:99], v[226:227], v[228:229] op_sel:[0,1,0] op_sel_hi:[1,1,0]
    v_pk_mul_f32 v[82:83], v[82:83], v[226:227] op_sel:[0,1] op_sel_hi:[1,1]
    v_pk_fma_f32 v[96:97], v[96:97], v[226:227], v[98:99] op_sel_hi:[1,0,1]
    v_pk_fma_f32 v[58:59], v[58:59], v[226:227], v[82:83] op_sel_hi:[1,0,1]
    v_cvt_pk_bf16_f32 v89, v96, v97
    v_cvt_pk_bf16_f32 v93, v58, v59
    v_pk_add_f32 v[96:97], v[60:61], v[68:69]
    v_pk_add_f32 v[60:61], v[60:61], v[68:69] neg_lo:[0,1] neg_hi:[0,1]
    v_pk_add_f32 v[98:99], v[84:85], v[76:77]
    v_pk_add_f32 v[84:85], v[84:85], v[76:77] neg_lo:[0,1] neg_hi:[0,1]
    v_pk_fma_f32 v[98:99], v[98:99], v[226:227], v[228:229] op_sel:[0,1,0] op_sel_hi:[1,1,0]
    v_pk_mul_f32 v[84:85], v[84:85], v[226:227] op_sel:[0,1] op_sel_hi:[1,1]
    v_pk_fma_f32 v[96:97], v[96:97], v[226:227], v[98:99] op_sel_hi:[1,0,1]
    v_pk_fma_f32 v[60:61], v[60:61], v[226:227], v[84:85] op_sel_hi:[1,0,1]
    v_cvt_pk_bf16_f32 v90, v96, v97
    v_cvt_pk_bf16_f32 v94, v60, v61
    v_pk_add_f32 v[96:97], v[62:63], v[70:71]
    v_pk_add_f32 v[62:63], v[62:63], v[70:71] neg_lo:[0,1] neg_hi:[0,1]
    v_pk_add_f32 v[98:99], v[86:87], v[78:79]
    v_pk_add_f32 v[86:87], v[86:87], v[78:79] neg_lo:[0,1] neg_hi:[0,1]
    v_pk_fma_f32 v[98:99], v[98:99], v[226:227], v[228:229] op_sel:[0,1,0] op_sel_hi:[1,1,0]
    v_pk_mul_f32 v[86:87], v[86:87], v[226:227] op_sel:[0,1] op_sel_hi:[1,1]
    v_pk_fma_f32 v[96:97], v[96:97], v[226:227], v[98:99] op_sel_hi:[1,0,1]
    v_pk_fma_f32 v[62:63], v[62:63], v[226:227], v[86:87] op_sel_hi:[1,0,1]
    v_cvt_pk_bf16_f32 v91, v96, v97
    v_cvt_pk_bf16_f32 v95, v62, v63
    s_mov_b64 s[36:37], exec
    s_mov_b64 exec, 0xffff
    ds_write_b64 v247, v[88:89] offset:4096
    ds_write_b64 v247, v[90:91] offset:4224
    ds_write_b64 v247, v[92:93] offset:13312
    ds_write_b64 v247, v[94:95] offset:13440
    s_mov_b64 exec, s[36:37]
    s_waitcnt lgkmcnt(0)
    s_barrier
    v_lshlrev_b32 v1, 4, v5
    v_lshlrev_b32 v2, 3, v5
    ds_read_b128 v[8:11], v1 offset:0
    ds_read_b128 v[26:29], v1 offset:4608
    ds_read_b128 v[44:47], v1 offset:9216
    ds_read_b128 v[62:65], v1 offset:13824
    ds_read_b128 v[12:15], v1 offset:1024
    ds_read_b128 v[30:33], v1 offset:5632
    ds_read_b128 v[48:51], v1 offset:10240
    ds_read_b128 v[66:69], v1 offset:14848
    ds_read_b128 v[16:19], v1 offset:2048
    ds_read_b128 v[34:37], v1 offset:6656
    ds_read_b128 v[52:55], v1 offset:11264
    ds_read_b128 v[70:73], v1 offset:15872
    ds_read_b128 v[20:23], v1 offset:3072
    ds_read_b128 v[38:41], v1 offset:7680
    ds_read_b128 v[56:59], v1 offset:12288
    ds_read_b128 v[74:77], v1 offset:16896
    ds_read_b64 v[24:25], v2 offset:4096
    ds_read_b64 v[42:43], v2 offset:8704
    ds_read_b64 v[60:61], v2 offset:13312
    ds_read_b64 v[78:79], v2 offset:17920
    s_mov_b32 s29, 73728
    v_mul_lo_u32 v3, v213, s29
    v_lshlrev_b32 v4, 4, v214
    s_mul_i32 s30, s24, 1152
    s_lshl_b32 s31, s26, 6
    s_add_u32 s30, s30, s31
    v_add3_u32 v3, v3, v4, s30
    s_waitcnt lgkmcnt(15)
    v_mfma_f32_16x16x32_bf16 v[80:83], v[8:11], v[104:107], 0
    v_mfma_f32_16x16x32_bf16 v[84:87], v[26:29], v[104:107], 0
    v_mfma_f32_16x16x32_bf16 v[88:91], v[44:47], v[122:125], 0
    v_mfma_f32_16x16x32_bf16 v[92:95], v[62:65], v[122:125], 0
    s_waitcnt lgkmcnt(12)
    v_mfma_f32_16x16x32_bf16 v[80:83], v[12:15], v[108:111], v[80:83]
    v_mfma_f32_16x16x32_bf16 v[84:87], v[30:33], v[108:111], v[84:87]
    v_mfma_f32_16x16x32_bf16 v[88:91], v[48:51], v[126:129], v[88:91]
    v_mfma_f32_16x16x32_bf16 v[92:95], v[66:69], v[126:129], v[92:95]
    s_waitcnt lgkmcnt(8)
    v_mfma_f32_16x16x32_bf16 v[80:83], v[16:19], v[112:115], v[80:83]
    v_mfma_f32_16x16x32_bf16 v[84:87], v[34:37], v[112:115], v[84:87]
    v_mfma_f32_16x16x32_bf16 v[88:91], v[52:55], v[130:133], v[88:91]
    v_mfma_f32_16x16x32_bf16 v[92:95], v[70:73], v[130:133], v[92:95]
    s_waitcnt lgkmcnt(4)
    v_mfma_f32_16x16x32_bf16 v[80:83], v[20:23], v[116:119], v[80:83]
    v_mfma_f32_16x16x32_bf16 v[84:87], v[38:41], v[116:119], v[84:87]
    v_mfma_f32_16x16x32_bf16 v[88:91], v[56:59], v[134:137], v[88:91]
    v_mfma_f32_16x16x32_bf16 v[92:95], v[74:77], v[134:137], v[92:95]
    s_waitcnt lgkmcnt(0)
    s_nop 1
    v_mfma_f32_16x16x16_bf16 v[80:83], v[24:25], v[120:121], v[80:83]
    v_mfma_f32_16x16x16_bf16 v[84:87], v[42:43], v[120:121], v[84:87]
    v_mfma_f32_16x16x16_bf16 v[88:91], v[60:61], v[138:139], v[88:91]
    v_mfma_f32_16x16x16_bf16 v[92:95], v[78:79], v[138:139], v[92:95]
    s_nop 4
    v_pk_mul_f32 v[96:97], v[80:81], v[200:201] op_sel_hi:[1,0]
    s_nop 0
    v_pk_fma_f32 v[96:97], v[88:89], v[200:201], v[96:97] op_sel:[0,1,0] op_sel_hi:[1,1,1]
    v_pk_mul_f32 v[88:89], v[88:89], v[200:201] op_sel_hi:[1,0]
    v_pk_fma_f32 v[88:89], v[80:81], v[200:201], v[88:89] op_sel:[0,1,0] op_sel_hi:[1,1,1] neg_lo:[1,0,0] neg_hi:[1,0,0]
    v_pk_mul_f32 v[98:99], v[82:83], v[200:201] op_sel_hi:[1,0]
    v_pk_fma_f32 v[98:99], v[90:91], v[200:201], v[98:99] op_sel:[0,1,0] op_sel_hi:[1,1,1]
    v_pk_mul_f32 v[90:91], v[90:91], v[200:201] op_sel_hi:[1,0]
    v_pk_fma_f32 v[90:91], v[82:83], v[200:201], v[90:91] op_sel:[0,1,0] op_sel_hi:[1,1,1] neg_lo:[1,0,0] neg_hi:[1,0,0]
    v_pk_mul_f32 v[100:101], v[84:85], v[200:201] op_sel_hi:[1,0]
    v_pk_fma_f32 v[100:101], v[92:93], v[200:201], v[100:101] op_sel:[0,1,0] op_sel_hi:[1,1,1]
    v_pk_mul_f32 v[92:93], v[92:93], v[200:201] op_sel_hi:[1,0]
    v_pk_fma_f32 v[92:93], v[84:85], v[200:201], v[92:93] op_sel:[0,1,0] op_sel_hi:[1,1,1] neg_lo:[1,0,0] neg_hi:[1,0,0]
    v_pk_mul_f32 v[102:103], v[86:87], v[200:201] op_sel_hi:[1,0]
    v_pk_fma_f32 v[102:103], v[94:95], v[200:201], v[102:103] op_sel:[0,1,0] op_sel_hi:[1,1,1]
    v_pk_mul_f32 v[94:95], v[94:95], v[200:201] op_sel_hi:[1,0]
    v_pk_fma_f32 v[94:95], v[86:87], v[200:201], v[94:95] op_sel:[0,1,0] op_sel_hi:[1,1,1] neg_lo:[1,0,0] neg_hi:[1,0,0]
    v_cvt_pk_bf16_f32 v80, v96, v97
    v_cvt_pk_bf16_f32 v81, v98, v99
    v_cvt_pk_bf16_f32 v82, v100, v101
    v_cvt_pk_bf16_f32 v83, v102, v103
    v_cvt_pk_bf16_f32 v84, v88, v89
    v_cvt_pk_bf16_f32 v85, v90, v91
    v_cvt_pk_bf16_f32 v86, v92, v93
    v_cvt_pk_bf16_f32 v87, v94, v95
    v_mfma_f32_16x16x32_bf16 v[88:91], v[80:83], v[176:179], 0
    v_mfma_f32_16x16x32_bf16 v[92:95], v[80:83], v[180:183], 0
    v_mfma_f32_16x16x32_bf16 v[96:99], v[80:83], v[188:191], 0
    v_mfma_f32_16x16x32_bf16 v[100:103], v[80:83], v[192:195], 0
    v_mfma_f32_16x16x32_bf16 v[88:91], v[84:87], v[184:187], v[88:91]
    v_mfma_f32_16x16x32_bf16 v[92:95], v[84:87], v[176:179], v[92:95]
    v_mfma_f32_16x16x32_bf16 v[96:99], v[84:87], v[196:199], v[96:99]
    v_mfma_f32_16x16x32_bf16 v[100:103], v[84:87], v[188:191], v[100:103]
    s_lshl_b32 s29, s32, 7
    s_nop 3
    v_cvt_pk_bf16_f32 v204, v88, v89
    v_cvt_pk_bf16_f32 v205, v90, v91
    v_cvt_pk_bf16_f32 v206, v92, v93
    v_cvt_pk_bf16_f32 v207, v94, v95
    s_add_u32 s30, s29, 0
    buffer_store_dwordx4 v[204:207], v3, s[20:23], s30 offen
    v_cvt_pk_bf16_f32 v208, v96, v97
    v_cvt_pk_bf16_f32 v209, v98, v99
    v_cvt_pk_bf16_f32 v210, v100, v101
    v_cvt_pk_bf16_f32 v211, v102, v103
    s_add_u32 s30, s29, 1179648
    buffer_store_dwordx4 v[208:211], v3, s[20:23], s30 offen
    s_cmp_eq_u32 s34, 0
    s_cbranch_scc0 k1_done
    v_mfma_f32_16x16x32_bf16 v[80:83], v[8:11], v[140:143], 0
    v_mfma_f32_16x16x32_bf16 v[84:87], v[26:29], v[140:143], 0
    v_mfma_f32_16x16x32_bf16 v[88:91], v[44:47], v[158:161], 0
    v_mfma_f32_16x16x32_bf16 v[92:95], v[62:65], v[158:161], 0
    v_mfma_f32_16x16x32_bf16 v[80:83], v[12:15], v[144:147], v[80:83]
    v_mfma_f32_16x16x32_bf16 v[84:87], v[30:33], v[144:147], v[84:87]
    v_mfma_f32_16x16x32_bf16 v[88:91], v[48:51], v[162:165], v[88:91]
    v_mfma_f32_16x16x32_bf16 v[92:95], v[66:69], v[162:165], v[92:95]
    v_mfma_f32_16x16x32_bf16 v[80:83], v[16:19], v[148:151], v[80:83]
    v_mfma_f32_16x16x32_bf16 v[84:87], v[34:37], v[148:151], v[84:87]
    v_mfma_f32_16x16x32_bf16 v[88:91], v[52:55], v[166:169], v[88:91]
    v_mfma_f32_16x16x32_bf16 v[92:95], v[70:73], v[166:169], v[92:95]
    v_mfma_f32_16x16x32_bf16 v[80:83], v[20:23], v[152:155], v[80:83]
    v_mfma_f32_16x16x32_bf16 v[84:87], v[38:41], v[152:155], v[84:87]
    v_mfma_f32_16x16x32_bf16 v[88:91], v[56:59], v[170:173], v[88:91]
    v_mfma_f32_16x16x32_bf16 v[92:95], v[74:77], v[170:173], v[92:95]
    s_nop 2
    v_mfma_f32_16x16x16_bf16 v[80:83], v[24:25], v[156:157], v[80:83]
    v_mfma_f32_16x16x16_bf16 v[84:87], v[42:43], v[156:157], v[84:87]
    v_mfma_f32_16x16x16_bf16 v[88:91], v[60:61], v[174:175], v[88:91]
    v_mfma_f32_16x16x16_bf16 v[92:95], v[78:79], v[174:175], v[92:95]
    s_nop 4
    v_pk_mul_f32 v[96:97], v[80:81], v[202:203] op_sel_hi:[1,0]
    s_nop 0
    v_pk_fma_f32 v[96:97], v[88:89], v[202:203], v[96:97] op_sel:[0,1,0] op_sel_hi:[1,1,1]
    v_pk_mul_f32 v[88:89], v[88:89], v[202:203] op_sel_hi:[1,0]
    v_pk_fma_f32 v[88:89], v[80:81], v[202:203], v[88:89] op_sel:[0,1,0] op_sel_hi:[1,1,1] neg_lo:[1,0,0] neg_hi:[1,0,0]
    v_pk_mul_f32 v[98:99], v[82:83], v[202:203] op_sel_hi:[1,0]
    v_pk_fma_f32 v[98:99], v[90:91], v[202:203], v[98:99] op_sel:[0,1,0] op_sel_hi:[1,1,1]
    v_pk_mul_f32 v[90:91], v[90:91], v[202:203] op_sel_hi:[1,0]
    v_pk_fma_f32 v[90:91], v[82:83], v[202:203], v[90:91] op_sel:[0,1,0] op_sel_hi:[1,1,1] neg_lo:[1,0,0] neg_hi:[1,0,0]
    v_pk_mul_f32 v[100:101], v[84:85], v[202:203] op_sel_hi:[1,0]
    v_pk_fma_f32 v[100:101], v[92:93], v[202:203], v[100:101] op_sel:[0,1,0] op_sel_hi:[1,1,1]
    v_pk_mul_f32 v[92:93], v[92:93], v[202:203] op_sel_hi:[1,0]
    v_pk_fma_f32 v[92:93], v[84:85], v[202:203], v[92:93] op_sel:[0,1,0] op_sel_hi:[1,1,1] neg_lo:[1,0,0] neg_hi:[1,0,0]
    v_pk_mul_f32 v[102:103], v[86:87], v[202:203] op_sel_hi:[1,0]
    v_pk_fma_f32 v[102:103], v[94:95], v[202:203], v[102:103] op_sel:[0,1,0] op_sel_hi:[1,1,1]
    v_pk_mul_f32 v[94:95], v[94:95], v[202:203] op_sel_hi:[1,0]
    v_pk_fma_f32 v[94:95], v[86:87], v[202:203], v[94:95] op_sel:[0,1,0] op_sel_hi:[1,1,1] neg_lo:[1,0,0] neg_hi:[1,0,0]
    v_cvt_pk_bf16_f32 v80, v96, v97
    v_cvt_pk_bf16_f32 v81, v98, v99
    v_cvt_pk_bf16_f32 v82, v100, v101
    v_cvt_pk_bf16_f32 v83, v102, v103
    v_cvt_pk_bf16_f32 v84, v88, v89
    v_cvt_pk_bf16_f32 v85, v90, v91
    v_cvt_pk_bf16_f32 v86, v92, v93
    v_cvt_pk_bf16_f32 v87, v94, v95
    v_mfma_f32_16x16x32_bf16 v[88:91], v[80:83], v[176:179], 0
    v_mfma_f32_16x16x32_bf16 v[92:95], v[80:83], v[180:183], 0
    v_mfma_f32_16x16x32_bf16 v[96:99], v[80:83], v[188:191], 0
    v_mfma_f32_16x16x32_bf16 v[100:103], v[80:83], v[192:195], 0
    v_mfma_f32_16x16x32_bf16 v[88:91], v[84:87], v[184:187], v[88:91]
    v_mfma_f32_16x16x32_bf16 v[92:95], v[84:87], v[176:179], v[92:95]
    v_mfma_f32_16x16x32_bf16 v[96:99], v[84:87], v[196:199], v[96:99]
    v_mfma_f32_16x16x32_bf16 v[100:103], v[84:87], v[188:191], v[100:103]
    s_lshl_b32 s29, s33, 7
    s_nop 3
    v_cvt_pk_bf16_f32 v204, v88, v89
    v_cvt_pk_bf16_f32 v205, v90, v91
    v_cvt_pk_bf16_f32 v206, v92, v93
    v_cvt_pk_bf16_f32 v207, v94, v95
    s_add_u32 s30, s29, 0
    buffer_store_dwordx4 v[204:207], v3, s[20:23], s30 offen
    v_cvt_pk_bf16_f32 v208, v96, v97
    v_cvt_pk_bf16_f32 v209, v98, v99
    v_cvt_pk_bf16_f32 v210, v100, v101
    v_cvt_pk_bf16_f32 v211, v102, v103
    s_add_u32 s30, s29, 1179648
    buffer_store_dwordx4 v[208:211], v3, s[20:23], s30 offen
k1_done:
    s_endpgm
k1_aux:
    s_cmp_ge_u32 s2, 448
    s_cbranch_scc1 k1_end
    s_load_dwordx2 s[4:5], s[0:1], 0
    s_load_dwordx4 s[36:39], s[0:1], 56
    s_load_dwordx2 s[40:41], s[0:1], 72
    s_load_dwordx2 s[42:43], s[0:1], 88
    s_load_dwordx2 s[8:9], s[0:1], 96
    s_sub_u32 s28, s2, 400
    s_cmp_lt_u32 s28, 48
    s_cbranch_scc0 k1_moe
    v_lshrrev_b32 v5, 6, v0
    s_nop 0
    v_readfirstlane_b32 s26, v5
    v_and_b32 v5, 63, v0
    s_waitcnt lgkmcnt(0)
    s_and_b32 s29, s28, 7
    s_lshr_b32 s30, s28, 3
    s_lshl_b32 s30, s30, 1
    s_lshr_b32 s33, s26, 1
    s_add_u32 s30, s30, s33
    s_and_b32 s33, s26, 1
    s_cmp_eq_u32 s33, 1
    s_cselect_b32 s44, s38, s36
    s_cselect_b32 s45, s39, s37
    s_mov_b32 s46, 5308416
    s_mov_b32 s47, 0x00020000
    s_mul_i32 s29, s29, 1152
    s_lshr_b32 s33, s30, 2
    s_mul_i32 s33, s33, 192
    s_and_b32 s34, s30, 3
    s_mul_i32 s34, s34, 24
    s_add_u32 s33, s33, s34
    s_add_u32 s33, s33, 96
    s_mul_i32 s30, s33, 9216
    s_add_u32 s29, s29, s30
    s_movk_i32 s31, 9216
    v_lshrrev_b32 v1, 3, v5
    v_mul_lo_u32 v1, v1, s31
    v_and_b32 v2, 7, v5
    v_lshl_add_u32 v1, v2, 4, v1
    s_lshl_b32 s31, s31, 3
    buffer_load_dwordx4 v[8:11], v1, s[44:47], s29 offen offset:0
    buffer_load_dwordx4 v[8:11], v1, s[44:47], s29 offen offset:128
    buffer_load_dwordx4 v[8:11], v1, s[44:47], s29 offen offset:256
    buffer_load_dwordx4 v[8:11], v1, s[44:47], s29 offen offset:384
    buffer_load_dwordx4 v[8:11], v1, s[44:47], s29 offen offset:512
    buffer_load_dwordx4 v[8:11], v1, s[44:47], s29 offen offset:640
    buffer_load_dwordx4 v[8:11], v1, s[44:47], s29 offen offset:768
    buffer_load_dwordx4 v[8:11], v1, s[44:47], s29 offen offset:896
    buffer_load_dwordx4 v[8:11], v1, s[44:47], s29 offen offset:1024
    s_add_u32 s29, s29, s31
    buffer_load_dwordx4 v[8:11], v1, s[44:47], s29 offen offset:0
    buffer_load_dwordx4 v[8:11], v1, s[44:47], s29 offen offset:128
    buffer_load_dwordx4 v[8:11], v1, s[44:47], s29 offen offset:256
    buffer_load_dwordx4 v[8:11], v1, s[44:47], s29 offen offset:384
    buffer_load_dwordx4 v[8:11], v1, s[44:47], s29 offen offset:512
    buffer_load_dwordx4 v[8:11], v1, s[44:47], s29 offen offset:640
    buffer_load_dwordx4 v[8:11], v1, s[44:47], s29 offen offset:768
    buffer_load_dwordx4 v[8:11], v1, s[44:47], s29 offen offset:896
    buffer_load_dwordx4 v[8:11], v1, s[44:47], s29 offen offset:1024
    s_add_u32 s29, s29, s31
    buffer_load_dwordx4 v[8:11], v1, s[44:47], s29 offen offset:0
    buffer_load_dwordx4 v[8:11], v1, s[44:47], s29 offen offset:128
    buffer_load_dwordx4 v[8:11], v1, s[44:47], s29 offen offset:256
    buffer_load_dwordx4 v[8:11], v1, s[44:47], s29 offen offset:384
    buffer_load_dwordx4 v[8:11], v1, s[44:47], s29 offen offset:512
    buffer_load_dwordx4 v[8:11], v1, s[44:47], s29 offen offset:640
    buffer_load_dwordx4 v[8:11], v1, s[44:47], s29 offen offset:768
    buffer_load_dwordx4 v[8:11], v1, s[44:47], s29 offen offset:896
    buffer_load_dwordx4 v[8:11], v1, s[44:47], s29 offen offset:1024
    s_waitcnt vmcnt(0)
    s_endpgm
k1_moe:
    s_sub_u32 s3, s2, 256
    s_and_b32 s29, s3, 7
    s_mul_i32 s29, s29, 18
    s_lshr_b32 s3, s3, 3
    s_add_u32 s3, s3, s29
    s_waitcnt lgkmcnt(0)
    v_lshrrev_b32 v5, 6, v0
    s_nop 0
    v_readfirstlane_b32 s26, v5
    v_and_b32 v5, 63, v0
    s_cmp_eq_u32 s26, 3
    s_cbranch_scc1 k1m_help
    s_mov_b32 s16, s40
    s_mov_b32 s17, s41
    s_mov_b32 s18, 5308416
    s_mov_b32 s19, 0x00020000
    s_mov_b32 s20, s8
    s_mov_b32 s21, s9
    s_mov_b32 s22, 4194304
    s_mov_b32 s23, 0x00020000
    v_and_b32 v6, 15, v5
    v_lshrrev_b32 v7, 4, v5
    v_and_b32 v1, 3, v6
    v_lshrrev_b32 v2, 2, v6
    v_and_b32 v2, 1, v2
    v_lshrrev_b32 v3, 3, v6
    v_lshlrev_b32 v4, 2, v2
    v_add_u32 v4, v4, v7
    s_mul_i32 s29, s26, 192
    v_add_u32 v4, s29, v4
    s_movk_i32 s30, 9216
    v_mul_lo_u32 v8, v4, s30
    v_lshlrev_b32 v9, 4, v1
    s_lshl_b32 s31, s3, 6
    v_add3_u32 v8, v8, v9, s31
    v_cmp_eq_u32 vcc, 1, v3
    v_mov_b32 v10, s36
    v_mov_b32 v11, s37
    v_mov_b32 v12, s38
    v_mov_b32 v13, s39
    v_cndmask_b32 v10, v10, v12, vcc
    v_cndmask_b32 v11, v11, v13, vcc
    v_add_co_u32 v10, vcc, v10, v8
    s_nop 1
    v_addc_co_u32 v11, vcc, 0, v11, vcc
    s_mov_b32 s29, 73728
    global_load_dwordx4 v[32:35], v[10:11], off
    v_add_co_u32 v10, vcc, s29, v10
    s_nop 1
    v_addc_co_u32 v11, vcc, 0, v11, vcc
    global_load_dwordx4 v[36:39], v[10:11], off
    v_add_co_u32 v10, vcc, s29, v10
    s_nop 1
    v_addc_co_u32 v11, vcc, 0, v11, vcc
    global_load_dwordx4 v[40:43], v[10:11], off
    v_add_co_u32 v10, vcc, s29, v10
    s_nop 1
    v_addc_co_u32 v11, vcc, 0, v11, vcc
    global_load_dwordx4 v[44:47], v[10:11], off
    v_add_co_u32 v10, vcc, s29, v10
    s_nop 1
    v_addc_co_u32 v11, vcc, 0, v11, vcc
    global_load_dwordx4 v[48:51], v[10:11], off
    v_add_co_u32 v10, vcc, s29, v10
    s_nop 1
    v_addc_co_u32 v11, vcc, 0, v11, vcc
    global_load_dwordx4 v[52:55], v[10:11], off
    v_add_co_u32 v10, vcc, s29, v10
    s_nop 1
    v_addc_co_u32 v11, vcc, 0, v11, vcc
    global_load_dwordx4 v[56:59], v[10:11], off
    v_add_co_u32 v10, vcc, s29, v10
    s_nop 1
    v_addc_co_u32 v11, vcc, 0, v11, vcc
    global_load_dwordx4 v[60:63], v[10:11], off
    v_add_co_u32 v10, vcc, s29, v10
    s_nop 1
    v_addc_co_u32 v11, vcc, 0, v11, vcc
    global_load_dwordx4 v[64:67], v[10:11], off
    v_add_co_u32 v10, vcc, s29, v10
    s_nop 1
    v_addc_co_u32 v11, vcc, 0, v11, vcc
    global_load_dwordx4 v[68:71], v[10:11], off
    v_add_co_u32 v10, vcc, s29, v10
    s_nop 1
    v_addc_co_u32 v11, vcc, 0, v11, vcc
    global_load_dwordx4 v[72:75], v[10:11], off
    v_add_co_u32 v10, vcc, s29, v10
    s_nop 1
    v_addc_co_u32 v11, vcc, 0, v11, vcc
    global_load_dwordx4 v[76:79], v[10:11], off
    v_add_co_u32 v10, vcc, s29, v10
    s_nop 1
    v_addc_co_u32 v11, vcc, 0, v11, vcc
    global_load_dwordx4 v[80:83], v[10:11], off
    v_add_co_u32 v10, vcc, s29, v10
    s_nop 1
    v_addc_co_u32 v11, vcc, 0, v11, vcc
    global_load_dwordx4 v[84:87], v[10:11], off
    v_add_co_u32 v10, vcc, s29, v10
    s_nop 1
    v_addc_co_u32 v11, vcc, 0, v11, vcc
    global_load_dwordx4 v[88:91], v[10:11], off
    v_add_co_u32 v10, vcc, s29, v10
    s_nop 1
    v_addc_co_u32 v11, vcc, 0, v11, vcc
    global_load_dwordx4 v[92:95], v[10:11], off
    v_add_co_u32 v10, vcc, s29, v10
    s_nop 1
    v_addc_co_u32 v11, vcc, 0, v11, vcc
    global_load_dwordx4 v[96:99], v[10:11], off
    v_add_co_u32 v10, vcc, s29, v10
    s_nop 1
    v_addc_co_u32 v11, vcc, 0, v11, vcc
    global_load_dwordx4 v[100:103], v[10:11], off
    v_add_co_u32 v10, vcc, s29, v10
    s_nop 1
    v_addc_co_u32 v11, vcc, 0, v11, vcc
    global_load_dwordx4 v[104:107], v[10:11], off
    v_add_co_u32 v10, vcc, s29, v10
    s_nop 1
    v_addc_co_u32 v11, vcc, 0, v11, vcc
    global_load_dwordx4 v[108:111], v[10:11], off
    v_add_co_u32 v10, vcc, s29, v10
    s_nop 1
    v_addc_co_u32 v11, vcc, 0, v11, vcc
    global_load_dwordx4 v[112:115], v[10:11], off
    v_add_co_u32 v10, vcc, s29, v10
    s_nop 1
    v_addc_co_u32 v11, vcc, 0, v11, vcc
    global_load_dwordx4 v[116:119], v[10:11], off
    v_add_co_u32 v10, vcc, s29, v10
    s_nop 1
    v_addc_co_u32 v11, vcc, 0, v11, vcc
    global_load_dwordx4 v[120:123], v[10:11], off
    v_add_co_u32 v10, vcc, s29, v10
    s_nop 1
    v_addc_co_u32 v11, vcc, 0, v11, vcc
    global_load_dwordx4 v[124:127], v[10:11], off
    v_lshrrev_b32 v1, 3, v6
    v_and_b32 v2, 7, v6
    v_lshlrev_b32 v1, 2, v1
    v_add_u32 v1, v1, v7
    s_lshl_b32 s29, s3, 5
    v_add_u32 v1, s29, v1
    s_movk_i32 s30, 1152
    v_mul_lo_u32 v1, v1, s30
    v_lshlrev_b32 v2, 4, v2
    s_mul_i32 s31, s26, 384
    v_add3_u32 v15, v1, v2, s31
    v_and_b32 v1, 7, v6
    v_and_b32 v2, 1, v1
    v_lshrrev_b32 v1, 1, v1
    v_mov_b32 v3, 0xffff
    v_mov_b32 v4, 0xffff0000
    v_cmp_eq_u32 vcc, 1, v2
    s_nop 1
    v_cndmask_b32 v3, v3, v4, vcc
    v_cmp_eq_u32 vcc, 0, v1
    s_nop 1
    v_cndmask_b32 v22, 0, v3, vcc
    v_cmp_eq_u32 vcc, 1, v1
    s_nop 1
    v_cndmask_b32 v23, 0, v3, vcc
    v_cmp_eq_u32 vcc, 2, v1
    s_nop 1
    v_cndmask_b32 v24, 0, v3, vcc
    v_cmp_eq_u32 vcc, 3, v1
    s_nop 1
    v_cndmask_b32 v25, 0, v3, vcc
    v_lshrrev_b32 v1, 3, v6
    v_lshlrev_b32 v1, 2, v1
    v_add_u32 v1, v1, v7
    v_lshlrev_b32 v1, 2, v1
    s_mul_i32 s29, s26, 768
    v_add_u32 v26, s29, v1
    s_lshl_b32 s29, s26, 7
    s_add_u32 s29, s29, 6144
    v_add_u32 v27, s29, v1
    s_barrier
    s_barrier
    s_mov_b32 s29, 0
    buffer_load_dwordx4 v[128:131], v15, s[16:19], s29 offen offset:0
    s_mov_b32 s29, 9216
    buffer_load_dwordx4 v[132:135], v15, s[16:19], s29 offen offset:0
    s_mov_b32 s29, 18432
    buffer_load_dwordx4 v[136:139], v15, s[16:19], s29 offen offset:0
    s_mov_b32 s29, 27648
    buffer_load_dwordx4 v[140:143], v15, s[16:19], s29 offen offset:0
    s_mov_b32 s29, 0
    buffer_load_dwordx4 v[144:147], v15, s[16:19], s29 offen offset:128
    s_mov_b32 s29, 9216
    buffer_load_dwordx4 v[148:151], v15, s[16:19], s29 offen offset:128
    s_mov_b32 s29, 18432
    buffer_load_dwordx4 v[152:155], v15, s[16:19], s29 offen offset:128
    s_mov_b32 s29, 27648
    buffer_load_dwordx4 v[156:159], v15, s[16:19], s29 offen offset:128
    s_mov_b32 s29, 0
    buffer_load_dwordx4 v[160:163], v15, s[16:19], s29 offen offset:256
    s_mov_b32 s29, 9216
    buffer_load_dwordx4 v[164:167], v15, s[16:19], s29 offen offset:256
    s_mov_b32 s29, 18432
    buffer_load_dwordx4 v[168:171], v15, s[16:19], s29 offen offset:256
    s_mov_b32 s29, 27648
    buffer_load_dwordx4 v[172:175], v15, s[16:19], s29 offen offset:256
    s_barrier
    ds_read_b32 v176, v26 offset:0
    ds_read_b32 v177, v26 offset:32
    ds_read_b32 v178, v26 offset:64
    ds_read_b32 v179, v26 offset:96
    ds_read_b32 v180, v26 offset:128
    ds_read_b32 v181, v26 offset:160
    ds_read_b32 v182, v26 offset:192
    ds_read_b32 v183, v26 offset:224
    ds_read_b32 v184, v26 offset:256
    ds_read_b32 v185, v26 offset:288
    ds_read_b32 v186, v26 offset:320
    ds_read_b32 v187, v26 offset:352
    ds_read_b32 v188, v26 offset:384
    ds_read_b32 v189, v26 offset:416
    ds_read_b32 v190, v26 offset:448
    ds_read_b32 v191, v26 offset:480
    ds_read_b32 v192, v26 offset:512
    ds_read_b32 v193, v26 offset:544
    ds_read_b32 v194, v26 offset:576
    ds_read_b32 v195, v26 offset:608
    ds_read_b32 v196, v26 offset:640
    ds_read_b32 v197, v26 offset:672
    ds_read_b32 v198, v26 offset:704
    ds_read_b32 v199, v26 offset:736
    s_waitcnt lgkmcnt(0)
    s_waitcnt vmcnt(32)
    v_and_b32 v200, v176, v22
    v_and_b32 v201, v176, v23
    v_and_b32 v202, v176, v24
    v_and_b32 v203, v176, v25
    s_nop 1
    v_mfma_f32_16x16x32_bf16 v[208:211], v[200:203], v[32:35], 0
    v_and_b32 v204, v177, v22
    v_and_b32 v205, v177, v23
    v_and_b32 v206, v177, v24
    v_and_b32 v207, v177, v25
    s_nop 1
    v_mfma_f32_16x16x32_bf16 v[212:215], v[204:207], v[36:39], 0
    v_and_b32 v200, v178, v22
    v_and_b32 v201, v178, v23
    v_and_b32 v202, v178, v24
    v_and_b32 v203, v178, v25
    s_nop 1
    v_mfma_f32_16x16x32_bf16 v[208:211], v[200:203], v[40:43], v[208:211]
    v_and_b32 v204, v179, v22
    v_and_b32 v205, v179, v23
    v_and_b32 v206, v179, v24
    v_and_b32 v207, v179, v25
    s_nop 1
    v_mfma_f32_16x16x32_bf16 v[212:215], v[204:207], v[44:47], v[212:215]
    s_waitcnt vmcnt(28)
    v_and_b32 v200, v180, v22
    v_and_b32 v201, v180, v23
    v_and_b32 v202, v180, v24
    v_and_b32 v203, v180, v25
    s_nop 1
    v_mfma_f32_16x16x32_bf16 v[208:211], v[200:203], v[48:51], v[208:211]
    v_and_b32 v204, v181, v22
    v_and_b32 v205, v181, v23
    v_and_b32 v206, v181, v24
    v_and_b32 v207, v181, v25
    s_nop 1
    v_mfma_f32_16x16x32_bf16 v[212:215], v[204:207], v[52:55], v[212:215]
    v_and_b32 v200, v182, v22
    v_and_b32 v201, v182, v23
    v_and_b32 v202, v182, v24
    v_and_b32 v203, v182, v25
    s_nop 1
    v_mfma_f32_16x16x32_bf16 v[208:211], v[200:203], v[56:59], v[208:211]
    v_and_b32 v204, v183, v22
    v_and_b32 v205, v183, v23
    v_and_b32 v206, v183, v24
    v_and_b32 v207, v183, v25
    s_nop 1
    v_mfma_f32_16x16x32_bf16 v[212:215], v[204:207], v[60:63], v[212:215]
    s_waitcnt vmcnt(24)
    v_and_b32 v200, v184, v22
    v_and_b32 v201, v184, v23
    v_and_b32 v202, v184, v24
    v_and_b32 v203, v184, v25
    s_nop 1
    v_mfma_f32_16x16x32_bf16 v[208:211], v[200:203], v[64:67], v[208:211]
    v_and_b32 v204, v185, v22
    v_and_b32 v205, v185, v23
    v_and_b32 v206, v185, v24
    v_and_b32 v207, v185, v25
    s_nop 1
    v_mfma_f32_16x16x32_bf16 v[212:215], v[204:207], v[68:71], v[212:215]
    v_and_b32 v200, v186, v22
    v_and_b32 v201, v186, v23
    v_and_b32 v202, v186, v24
    v_and_b32 v203, v186, v25
    s_nop 1
    v_mfma_f32_16x16x32_bf16 v[208:211], v[200:203], v[72:75], v[208:211]
    v_and_b32 v204, v187, v22
    v_and_b32 v205, v187, v23
    v_and_b32 v206, v187, v24
    v_and_b32 v207, v187, v25
    s_nop 1
    v_mfma_f32_16x16x32_bf16 v[212:215], v[204:207], v[76:79], v[212:215]
    s_waitcnt vmcnt(20)
    v_and_b32 v200, v188, v22
    v_and_b32 v201, v188, v23
    v_and_b32 v202, v188, v24
    v_and_b32 v203, v188, v25
    s_nop 1
    v_mfma_f32_16x16x32_bf16 v[208:211], v[200:203], v[80:83], v[208:211]
    v_and_b32 v204, v189, v22
    v_and_b32 v205, v189, v23
    v_and_b32 v206, v189, v24
    v_and_b32 v207, v189, v25
    s_nop 1
    v_mfma_f32_16x16x32_bf16 v[212:215], v[204:207], v[84:87], v[212:215]
    v_and_b32 v200, v190, v22
    v_and_b32 v201, v190, v23
    v_and_b32 v202, v190, v24
    v_and_b32 v203, v190, v25
    s_nop 1
    v_mfma_f32_16x16x32_bf16 v[208:211], v[200:203], v[88:91], v[208:211]
    v_and_b32 v204, v191, v22
    v_and_b32 v205, v191, v23
    v_and_b32 v206, v191, v24
    v_and_b32 v207, v191, v25
    s_nop 1
    v_mfma_f32_16x16x32_bf16 v[212:215], v[204:207], v[92:95], v[212:215]
    s_waitcnt vmcnt(16)
    v_and_b32 v200, v192, v22
    v_and_b32 v201, v192, v23
    v_and_b32 v202, v192, v24
    v_and_b32 v203, v192, v25
    s_nop 1
    v_mfma_f32_16x16x32_bf16 v[208:211], v[200:203], v[96:99], v[208:211]
    v_and_b32 v204, v193, v22
    v_and_b32 v205, v193, v23
    v_and_b32 v206, v193, v24
    v_and_b32 v207, v193, v25
    s_nop 1
    v_mfma_f32_16x16x32_bf16 v[212:215], v[204:207], v[100:103], v[212:215]
    v_and_b32 v200, v194, v22
    v_and_b32 v201, v194, v23
    v_and_b32 v202, v194, v24
    v_and_b32 v203, v194, v25
    s_nop 1
    v_mfma_f32_16x16x32_bf16 v[208:211], v[200:203], v[104:107], v[208:211]
    v_and_b32 v204, v195, v22
    v_and_b32 v205, v195, v23
    v_and_b32 v206, v195, v24
    v_and_b32 v207, v195, v25
    s_nop 1
    v_mfma_f32_16x16x32_bf16 v[212:215], v[204:207], v[108:111], v[212:215]
    s_waitcnt vmcnt(12)
    v_and_b32 v200, v196, v22
    v_and_b32 v201, v196, v23
    v_and_b32 v202, v196, v24
    v_and_b32 v203, v196, v25
    s_nop 1
    v_mfma_f32_16x16x32_bf16 v[208:211], v[200:203], v[112:115], v[208:211]
    v_and_b32 v204, v197, v22
    v_and_b32 v205, v197, v23
    v_and_b32 v206, v197, v24
    v_and_b32 v207, v197, v25
    s_nop 1
    v_mfma_f32_16x16x32_bf16 v[212:215], v[204:207], v[116:119], v[212:215]
    v_and_b32 v200, v198, v22
    v_and_b32 v201, v198, v23
    v_and_b32 v202, v198, v24
    v_and_b32 v203, v198, v25
    s_nop 1
    v_mfma_f32_16x16x32_bf16 v[208:211], v[200:203], v[120:123], v[208:211]
    v_and_b32 v204, v199, v22
    v_and_b32 v205, v199, v23
    v_and_b32 v206, v199, v24
    v_and_b32 v207, v199, v25
    s_nop 1
    v_mfma_f32_16x16x32_bf16 v[212:215], v[204:207], v[124:127], v[212:215]
    s_nop 7
    v_pk_add_f32 v[208:209], v[208:209], v[212:213]
    v_pk_add_f32 v[210:211], v[210:211], v[214:215]
    v_lshrrev_b32 v1, 1, v7
    v_lshrrev_b32 v2, 2, v6
    v_and_b32 v2, 1, v2
    v_cmp_eq_u32 vcc, v1, v2
    v_lshlrev_b32 v1, 8, v1
    v_lshrrev_b32 v3, 3, v6
    v_lshlrev_b32 v3, 7, v3
    v_and_b32 v4, 3, v6
    v_lshlrev_b32 v4, 5, v4
    v_add3_u32 v1, v1, v3, v4
    v_and_b32 v3, 1, v7
    v_lshlrev_b32 v3, 4, v3
    s_lshl_b32 s29, s26, 9
    v_add3_u32 v1, v1, v3, s29
    s_and_saveexec_b64 s[30:31], vcc
    ds_write_b128 v1, v[208:211] offset:4096
    s_mov_b64 exec, s[30:31]
    v_and_b32 v1, 31, v5
    v_lshrrev_b32 v2, 5, v5
    v_lshlrev_b32 v1, 2, v1
    v_lshlrev_b32 v2, 7, v2
    v_add_u32 v1, v1, v2
    s_waitcnt lgkmcnt(0)
    s_barrier
    ds_read_b32 v176, v1 offset:4096
    ds_read_b32 v177, v1 offset:4352
    ds_read_b32 v178, v1 offset:4608
    ds_read_b32 v179, v1 offset:4864
    ds_read_b32 v180, v1 offset:5120
    ds_read_b32 v181, v1 offset:5376
    s_waitcnt lgkmcnt(0)
    v_add_f32 v176, v176, v177
    v_add_f32 v178, v178, v179
    v_add_f32 v180, v180, v181
    v_add_f32 v176, v176, v178
    v_add_f32 v176, v176, v180
    v_mov_b32 v177, v176
    s_nop 1
    v_permlane32_swap_b32 v176, v177
    v_cvt_pk_bf16_f32 v176, v176, v177
    v_and_b32 v177, 0xffff0000, v176
    v_lshlrev_b32 v176, 16, v176
    v_mul_f32 v178, 0xbfb8aa3b, v176
    v_exp_f32 v178, v178
    s_nop 0
    v_add_f32 v178, 1.0, v178
    v_rcp_f32 v178, v178
    s_nop 0
    v_mul_f32 v178, v176, v178
    v_cvt_pk_bf16_f32 v178, v178, v178
    v_lshlrev_b32 v178, 16, v178
    v_mul_f32 v178, v178, v177
    v_cvt_pk_bf16_f32 v178, v178, v178
    v_and_b32 v1, 31, v5
    v_lshlrev_b32 v1, 2, v1
    s_lshl_b32 s29, s26, 7
    s_add_u32 s29, s29, 6144
    v_add_u32 v1, s29, v1
    ds_write_b32 v1, v178
    s_waitcnt lgkmcnt(0)
    ds_read_b32 v180, v27 offset:0
    ds_read_b32 v181, v27 offset:32
    ds_read_b32 v182, v27 offset:64
    ds_read_b32 v183, v27 offset:96
    s_waitcnt lgkmcnt(0)
    v_and_b32 v200, v180, v22
    v_and_b32 v201, v180, v23
    v_and_b32 v202, v180, v24
    v_and_b32 v203, v180, v25
    v_and_b32 v204, v181, v22
    v_and_b32 v205, v181, v23
    v_and_b32 v206, v181, v24
    v_and_b32 v207, v181, v25
    v_and_b32 v208, v182, v22
    v_and_b32 v209, v182, v23
    v_and_b32 v210, v182, v24
    v_and_b32 v211, v182, v25
    v_and_b32 v212, v183, v22
    v_and_b32 v213, v183, v23
    v_and_b32 v214, v183, v24
    v_and_b32 v215, v183, v25
    s_waitcnt vmcnt(0)
    v_mfma_f32_16x16x32_bf16 v[220:223], v[200:203], v[128:131], 0
    v_mfma_f32_16x16x32_bf16 v[224:227], v[200:203], v[144:147], 0
    v_mfma_f32_16x16x32_bf16 v[228:231], v[200:203], v[160:163], 0
    v_mfma_f32_16x16x32_bf16 v[220:223], v[204:207], v[132:135], v[220:223]
    v_mfma_f32_16x16x32_bf16 v[224:227], v[204:207], v[148:151], v[224:227]
    v_mfma_f32_16x16x32_bf16 v[228:231], v[204:207], v[164:167], v[228:231]
    v_mfma_f32_16x16x32_bf16 v[220:223], v[208:211], v[136:139], v[220:223]
    v_mfma_f32_16x16x32_bf16 v[224:227], v[208:211], v[152:155], v[224:227]
    v_mfma_f32_16x16x32_bf16 v[228:231], v[208:211], v[168:171], v[228:231]
    v_mfma_f32_16x16x32_bf16 v[220:223], v[212:215], v[140:143], v[220:223]
    v_mfma_f32_16x16x32_bf16 v[224:227], v[212:215], v[156:159], v[224:227]
    v_mfma_f32_16x16x32_bf16 v[228:231], v[212:215], v[172:175], v[228:231]
    v_cmp_gt_u32 vcc, 8, v6
    v_cmp_gt_u32 s[34:35], 32, v5
    s_and_b64 s[34:35], s[34:35], vcc
    v_lshlrev_b32 v3, 5, v6
    v_and_b32 v4, 1, v7
    v_lshlrev_b32 v4, 4, v4
    v_add_u32 v1, v3, v4
    s_mul_i32 s30, s26, 768
    v_add_u32 v1, s30, v1
    s_mul_i32 s29, s3, 2560
    s_add_u32 s29, s29, 2424832
    v_add_u32 v28, 0, v1
    v_add_u32 v29, 256, v1
    v_add_u32 v30, 512, v1
    v_mov_b32 v2, 256
    v_mov_b32 v3, 124
    v_cmp_gt_u32 vcc, 1152, v28
    s_nop 1
    v_cndmask_b32 v4, v2, v3, vcc
    v_add_u32 v28, v4, v28
    v_cmp_gt_u32 vcc, 1152, v29
    s_nop 1
    v_cndmask_b32 v4, v2, v3, vcc
    v_add_u32 v29, v4, v29
    v_cmp_gt_u32 vcc, 1152, v30
    s_nop 1
    v_cndmask_b32 v4, v2, v3, vcc
    v_add_u32 v30, v4, v30
    v_mov_b32 v176, v220
    v_mov_b32 v177, v221
    v_mov_b32 v178, v222
    v_mov_b32 v179, v223
    v_mov_b32 v180, v224
    v_mov_b32 v181, v225
    v_mov_b32 v182, v226
    v_mov_b32 v183, v227
    v_mov_b32 v184, v228
    v_mov_b32 v185, v229
    v_mov_b32 v186, v230
    v_mov_b32 v187, v231
    v_permlane32_swap_b32 v220, v176
    v_permlane32_swap_b32 v221, v177
    v_permlane32_swap_b32 v222, v178
    v_permlane32_swap_b32 v223, v179
    v_permlane32_swap_b32 v224, v180
    v_permlane32_swap_b32 v225, v181
    v_permlane32_swap_b32 v226, v182
    v_permlane32_swap_b32 v227, v183
    v_permlane32_swap_b32 v228, v184
    v_permlane32_swap_b32 v229, v185
    v_permlane32_swap_b32 v230, v186
    v_permlane32_swap_b32 v231, v187
    v_add_f32 v220, v176, v220 row_ror:8 row_mask:0xf bank_mask:0xf
    v_add_f32 v221, v177, v221 row_ror:8 row_mask:0xf bank_mask:0xf
    v_add_f32 v222, v178, v222 row_ror:8 row_mask:0xf bank_mask:0xf
    v_add_f32 v223, v179, v223 row_ror:8 row_mask:0xf bank_mask:0xf
    v_add_f32 v224, v180, v224 row_ror:8 row_mask:0xf bank_mask:0xf
    v_add_f32 v225, v181, v225 row_ror:8 row_mask:0xf bank_mask:0xf
    v_add_f32 v226, v182, v226 row_ror:8 row_mask:0xf bank_mask:0xf
    v_add_f32 v227, v183, v227 row_ror:8 row_mask:0xf bank_mask:0xf
    v_add_f32 v228, v184, v228 row_ror:8 row_mask:0xf bank_mask:0xf
    v_add_f32 v229, v185, v229 row_ror:8 row_mask:0xf bank_mask:0xf
    v_add_f32 v230, v186, v230 row_ror:8 row_mask:0xf bank_mask:0xf
    v_add_f32 v231, v187, v231 row_ror:8 row_mask:0xf bank_mask:0xf
    s_mov_b64 exec, s[34:35]
    buffer_store_dwordx4 v[220:223], v28, s[20:23], s29 offen
    buffer_store_dwordx4 v[224:227], v29, s[20:23], s29 offen
    buffer_store_dwordx4 v[228:231], v30, s[20:23], s29 offen
    s_cmp_eq_u32 s26, 1
    s_cbranch_scc0 k1m_done
    s_mov_b64 exec, 16
    v_mov_b32 v1, 1276
    buffer_store_dwordx4 v[224:227], v1, s[20:23], s29 offen
    s_branch k1m_done
k1m_help:
    s_mov_b32 s48, s42
    s_mov_b32 s49, s43
    s_mov_b32 s50, 256
    s_mov_b32 s51, 0x00020000
    s_mov_b32 s12, s4
    s_mov_b32 s13, s5
    s_mov_b32 s14, 2359296
    s_mov_b32 s15, 0x00020000
    s_mov_b32 s20, s8
    s_mov_b32 s21, s9
    s_mov_b32 s22, 4194304
    s_mov_b32 s23, 0x00020000
    v_lshlrev_b32 v1, 2, v5
    s_mov_b32 s30, 20000
    s_mov_b32 s35, 0x3f803f80
    v_mov_b32 v20, 0
    v_mov_b32 v21, 0
    v_mov_b32 v12, 0
    v_lshlrev_b32 v2, 3, v5
    s_barrier
k1m_poll:
    buffer_load_dword v16, v1, s[48:51], 0 offen sc1
    s_waitcnt vmcnt(0)
    v_cmp_eq_u32 vcc, 0, v16
    s_cbranch_vccz k1m_got
    s_sub_u32 s30, s30, 1
    s_cmp_eq_u32 s30, 0
    s_cbranch_scc1 k1m_got
    s_sleep 4
    s_branch k1m_poll
k1m_got:
    v_max_u32 v16, v16, v16 quad_perm:[1,0,3,2] row_mask:0xf bank_mask:0xf
    s_nop 1
    v_max_u32 v16, v16, v16 quad_perm:[2,3,0,1] row_mask:0xf bank_mask:0xf
    s_nop 1
    v_max_u32 v16, v16, v16 row_half_mirror row_mask:0xf bank_mask:0xf
    s_nop 1
    v_max_u32 v16, v16, v16 row_mirror row_mask:0xf bank_mask:0xf
    v_mov_b32 v17, v16
    s_nop 1
    v_permlane16_swap_b32 v16, v17
    v_max_u32 v16, v16, v17
    v_mov_b32 v17, v16
    s_nop 1
    v_permlane32_swap_b32 v16, v17
    v_max_u32 v16, v16, v17
    s_nop 0
    v_readfirstlane_b32 s31, v16
    s_and_b32 s27, s31, 0x7ff
    s_sub_u32 s27, 2047, s27
    s_mul_i32 s29, s27, 1152
    buffer_load_dword v8, v1, s[12:15], s29 offen offset:0
    buffer_load_dword v9, v1, s[12:15], s29 offen offset:256
    buffer_load_dword v10, v1, s[12:15], s29 offen offset:512
    buffer_load_dword v11, v1, s[12:15], s29 offen offset:768
    s_mov_b32 s50, -1
    s_mov_b32 s51, 0
    s_mov_b64 exec, s[50:51]
    buffer_load_dword v12, v1, s[12:15], s29 offen offset:1024
    s_mov_b64 exec, -1
    s_barrier
    s_and_b32 s32, s31, 0xfffff800
    s_xor_b32 s33, s32, 0x80000000
    s_not_b32 s34, s31
    s_or_b32 s34, s34, 0x400
    s_and_b32 s34, s34, 0xfffffc00
    s_cmp_lt_i32 s31, 0
    s_cselect_b32 s32, s33, s34
    v_mov_b32 v18, s27
    v_mov_b32 v19, s32
    v_mov_b32 v3, 2396160
    s_waitcnt vmcnt(0)
    v_dot2_f32_bf16 v20, v8, s35, v20
    v_dot2_f32_bf16 v21, v8, v8, v21
    v_dot2_f32_bf16 v20, v9, s35, v20
    v_dot2_f32_bf16 v21, v9, v9, v21
    v_dot2_f32_bf16 v20, v10, s35, v20
    v_dot2_f32_bf16 v21, v10, v10, v21
    v_dot2_f32_bf16 v20, v11, s35, v20
    v_dot2_f32_bf16 v21, v11, v11, v21
    v_dot2_f32_bf16 v20, v12, s35, v20
    v_dot2_f32_bf16 v21, v12, v12, v21
    s_nop 1
    v_add_f32 v20, v20, v20 quad_perm:[1,0,3,2] row_mask:0xf bank_mask:0xf
    v_add_f32 v21, v21, v21 quad_perm:[1,0,3,2] row_mask:0xf bank_mask:0xf
    s_nop 0
    v_add_f32 v20, v20, v20 quad_perm:[2,3,0,1] row_mask:0xf bank_mask:0xf
    v_add_f32 v21, v21, v21 quad_perm:[2,3,0,1] row_mask:0xf bank_mask:0xf
    s_nop 0
    v_add_f32 v20, v20, v20 row_half_mirror row_mask:0xf bank_mask:0xf
    v_add_f32 v21, v21, v21 row_half_mirror row_mask:0xf bank_mask:0xf
    s_nop 0
    v_add_f32 v20, v20, v20 row_mirror row_mask:0xf bank_mask:0xf
    v_add_f32 v21, v21, v21 row_mirror row_mask:0xf bank_mask:0xf
    v_mov_b32 v22, v20
    v_mov_b32 v23, v21
    s_nop 0
    v_permlane16_swap_b32 v20, v22
    v_permlane16_swap_b32 v21, v23
    v_add_f32 v20, v20, v22
    v_add_f32 v21, v21, v23
    v_mov_b32 v22, v20
    v_mov_b32 v23, v21
    s_nop 0
    v_permlane32_swap_b32 v20, v22
    v_permlane32_swap_b32 v21, v23
    v_add_f32 v20, v20, v22
    v_add_f32 v21, v21, v23
    v_mul_f32 v20, 0x3ae38e39, v20
    v_mul_f32 v21, 0x3ae38e39, v21
    v_fma_f32 v21, -v20, v20, v21
    v_max_f32 v21, 0, v21
    v_add_f32 v21, 0x3727c5ac, v21
    v_rsq_f32 v21, v21
    v_lshlrev_b32 v24, 16, v8
    v_and_b32 v25, 0xffff0000, v8
    v_sub_f32 v24, v24, v20
    v_sub_f32 v25, v25, v20
    v_mul_f32 v24, v24, v21
    v_mul_f32 v25, v25, v21
    v_cvt_pk_bf16_f32 v28, v24, v24
    v_cvt_pk_bf16_f32 v29, v25, v25
    ds_write_b64 v2, v[28:29] offset:0
    v_lshlrev_b32 v24, 16, v9
    v_and_b32 v25, 0xffff0000, v9
    v_sub_f32 v24, v24, v20
    v_sub_f32 v25, v25, v20
    v_mul_f32 v24, v24, v21
    v_mul_f32 v25, v25, v21
    v_cvt_pk_bf16_f32 v30, v24, v24
    v_cvt_pk_bf16_f32 v31, v25, v25
    ds_write_b64 v2, v[30:31] offset:512
    v_lshlrev_b32 v24, 16, v10
    v_and_b32 v25, 0xffff0000, v10
    v_sub_f32 v24, v24, v20
    v_sub_f32 v25, v25, v20
    v_mul_f32 v24, v24, v21
    v_mul_f32 v25, v25, v21
    v_cvt_pk_bf16_f32 v32, v24, v24
    v_cvt_pk_bf16_f32 v33, v25, v25
    ds_write_b64 v2, v[32:33] offset:1024
    v_lshlrev_b32 v24, 16, v11
    v_and_b32 v25, 0xffff0000, v11
    v_sub_f32 v24, v24, v20
    v_sub_f32 v25, v25, v20
    v_mul_f32 v24, v24, v21
    v_mul_f32 v25, v25, v21
    v_cvt_pk_bf16_f32 v34, v24, v24
    v_cvt_pk_bf16_f32 v35, v25, v25
    ds_write_b64 v2, v[34:35] offset:1536
    v_lshlrev_b32 v24, 16, v12
    v_and_b32 v25, 0xffff0000, v12
    v_sub_f32 v24, v24, v20
    v_sub_f32 v25, v25, v20
    v_mul_f32 v24, v24, v21
    v_mul_f32 v25, v25, v21
    v_cvt_pk_bf16_f32 v36, v24, v24
    v_cvt_pk_bf16_f32 v37, v25, v25
    s_mov_b64 exec, s[50:51]
    ds_write_b64 v2, v[36:37] offset:2048
    s_mov_b64 exec, -1
    s_waitcnt lgkmcnt(0)
    s_barrier
    s_cmp_eq_u32 s3, 0
    s_cbranch_scc0 k1m_done
    s_mov_b64 exec, 1
    buffer_store_dwordx2 v[18:19], v3, s[20:23], 0 offen
    s_mov_b64 exec, -1
k1m_done:
k1_end:
    s_endpgm
.globl k2_kernel
.p2align 8
.type k2_kernel,@function
k2_kernel:
    s_cmp_ge_u32 s2, 288
    s_cbranch_scc1 k2_end
    s_load_dwordx2 s[4:5], s[0:1], 0
    s_load_dwordx2 s[10:11], s[0:1], 80
    s_load_dwordx2 s[8:9], s[0:1], 96
    s_mov_b32 s3, s2
    s_waitcnt lgkmcnt(0)
    s_mov_b32 s46, 0x249000
    s_load_dwordx2 s[44:45], s[8:9], s46
    s_mov_b32 s12, s4
    s_mov_b32 s13, s5
    s_mov_b32 s14, 2359296
    s_mov_b32 s15, 0x00020000
    s_mov_b32 s16, s10
    s_mov_b32 s17, s11
    s_mov_b32 s18, 2359296
    s_mov_b32 s19, 0x00020000
    s_mov_b32 s20, s8
    s_mov_b32 s21, s9
    s_mov_b32 s22, 4194304
    s_mov_b32 s23, 0x00020000
    s_and_b32 s29, s3, 31
    s_lshr_b32 s25, s3, 5
    s_xor_b32 s30, s25, 1
    s_cmp_lt_u32 s25, 2
    s_cselect_b32 s25, s30, s25
    s_xor_b32 s30, s29, 16
    s_cmp_eq_u32 s25, 8
    s_cselect_b32 s29, s30, s29
    s_mov_b32 s34, 0
    s_mov_b32 s35, 12
    s_cmp_eq_u32 s25, 8
    s_cselect_b32 s34, 1, s34
    s_cbranch_scc1 k2p_sw
    s_cmp_eq_u32 s25, 4
    s_cbranch_scc1 k2p_sw
    s_mov_b32 s35, 6
    s_cmp_eq_u32 s25, 1
    s_cselect_b32 s34, 1, s34
    s_cbranch_scc1 k2p_sw
    s_cmp_eq_u32 s25, 5
    s_cbranch_scc1 k2p_sw
    s_branch k2p_nsw
k2p_sw:
    s_xor_b32 s31, s29, 16
    s_cmp_eq_u32 s34, 1
    s_cselect_b32 s30, s29, s31
    s_and_b32 s31, s30, 7
    s_lshr_b32 s32, s30, 3
    s_lshl_b32 s31, s31, 1
    s_lshr_b32 s32, s32, 1
    s_add_u32 s31, s31, s32
    s_waitcnt lgkmcnt(0)
    s_and_b32 s32, s44, 31
    s_sub_u32 s33, 32, s32
    s_min_u32 s33, s32, s33
    s_cmp_eq_u32 s32, 16
    s_cselect_b32 s33, 0, s33
    s_cmp_eq_u32 s33, s31
    s_cbranch_scc0 k2p_nsw
    s_xor_b32 s29, s29, 16
    s_sub_u32 s25, s35, s25
k2p_nsw:
    s_and_b32 s30, s29, 7
    s_lshr_b32 s31, s29, 3
    s_lshl_b32 s30, s30, 1
    s_lshr_b32 s32, s31, 1
    s_add_u32 s30, s30, s32
    s_sub_u32 s32, 32, s30
    s_cmp_eq_u32 s30, 0
    s_cselect_b32 s32, 16, s32
    s_and_b32 s31, s31, 1
    s_cmp_eq_u32 s31, 1
    s_cselect_b32 s24, s32, s30
    v_lshrrev_b32 v5, 6, v0
    s_nop 0
    v_readfirstlane_b32 s26, v5
    v_and_b32 v5, 63, v0
    v_lshrrev_b32 v1, 3, v0
    v_and_b32 v2, 7, v0
    s_movk_i32 s29, 1152
    v_mul_lo_u32 v3, v1, s29
    v_lshlrev_b32 v4, 4, v2
    s_mul_i32 s30, s24, 73728
    s_lshl_b32 s31, s25, 7
    s_add_u32 s30, s30, s31
    v_add3_u32 v3, v3, v4, s30
    buffer_load_dwordx4 v[8:11], v3, s[20:23], 0 offen
    s_mov_b32 s31, 36864
    buffer_load_dwordx4 v[12:15], v3, s[20:23], s31 offen
    v_lshrrev_b32 v4, 2, v2
    v_mul_u32_u24 v4, 4224, v4
    v_and_b32 v6, 3, v2
    v_lshlrev_b32 v6, 3, v6
    v_lshlrev_b32 v7, 5, v1
    v_add3_u32 v4, v4, v6, v7
    v_lshrrev_b32 v16, 2, v5
    v_and_b32 v17, 3, v5
    s_lshl_b32 s29, s26, 4
    v_add_u32 v18, s29, v16
    v_lshlrev_b32 v18, 5, v18
    v_add_u32 v18, s24, v18
    v_sub_u32 v19, 2048, v18
    v_and_b32 v19, 2047, v19
    s_movk_i32 s29, 1152
    v_mul_lo_u32 v20, v18, s29
    v_mul_lo_u32 v21, v19, s29
    v_lshlrev_b32 v22, 4, v17
    s_lshl_b32 s30, s25, 6
    s_add_u32 s31, s30, 2
    v_add3_u32 v20, v20, v22, s31
    s_sub_u32 s31, 1136, s30
    v_sub_u32 v21, v21, v22
    v_add_u32 v21, s31, v21
    buffer_load_dwordx4 v[24:27], v20, s[12:15], 0 offen
    buffer_load_dwordx4 v[28:31], v21, s[12:15], 0 offen
    v_and_b32 v22, 31, v18
    v_lshrrev_b32 v23, 5, v18
    v_lshl_add_u32 v22, v22, 6, v23
    v_lshlrev_b32 v22, 3, v22
    v_and_b32 v23, 31, v19
    v_lshrrev_b32 v36, 5, v19
    v_lshl_add_u32 v23, v23, 6, v36
    v_lshlrev_b32 v23, 3, v23
    s_mov_b32 s31, 2359296
    buffer_load_dwordx2 v[32:33], v22, s[20:23], s31 offen
    buffer_load_dwordx2 v[34:35], v23, s[20:23], s31 offen
    v_and_b32 v38, 15, v5
    v_lshrrev_b32 v39, 4, v5
    v_lshrrev_b32 v120, 2, v5
    v_lshl_add_u32 v120, v17, 4, v120
    v_lshlrev_b32 v120, 2, v120
    v_subrev_u32 v36, 2, v20
    s_cmp_eq_u32 s25, 0
    s_cbranch_scc0 k2p_nc0
    buffer_load_ushort v37, v36, s[12:15], 0 offen
k2p_nc0:
    s_lshl_b32 s29, s26, 4
    v_add_u32 v56, s29, v38
    v_cvt_f32_u32 v56, v56
    v_mul_f32 v58, 0x3c800000, v56
    v_cos_f32 v60, v58
    v_cvt_f32_u32 v62, v39
    v_mul_f32 v62, 4.0, v62
    v_mul_f32 v57, v62, v58
    v_add_f32 v60, v60, v60
    v_and_b32 v63, 1, v38
    v_mul_u32_u24 v63, 0x8000, v63
    v_lshlrev_b32 v61, 16, v63
    v_or_b32 v63, v63, v61
    v_mov_b32 v59, 0x80008000
    v_cos_f32 v40, v57
    v_sin_f32 v41, v57
    v_add_f32 v57, v57, v58
    v_cos_f32 v42, v57
    v_sin_f32 v43, v57
    s_nop 0
    v_pk_fma_f32 v[44:45], v[60:61], v[42:43], v[40:41] op_sel_hi:[0,1,1] neg_lo:[0,0,1] neg_hi:[0,0,1]
    v_pk_fma_f32 v[46:47], v[60:61], v[44:45], v[42:43] op_sel_hi:[0,1,1] neg_lo:[0,0,1] neg_hi:[0,0,1]
    v_cvt_pk_bf16_f32 v64, v40, v42
    v_cvt_pk_bf16_f32 v72, v41, v43
    v_cvt_pk_bf16_f32 v65, v44, v46
    v_cvt_pk_bf16_f32 v73, v45, v47
    v_add_f32 v62, 0x41800000, v62
    v_mul_f32 v57, v62, v58
    v_cos_f32 v40, v57
    v_sin_f32 v41, v57
    v_add_f32 v57, v57, v58
    v_cos_f32 v42, v57
    v_sin_f32 v43, v57
    s_nop 0
    v_pk_fma_f32 v[44:45], v[60:61], v[42:43], v[40:41] op_sel_hi:[0,1,1] neg_lo:[0,0,1] neg_hi:[0,0,1]
    v_pk_fma_f32 v[46:47], v[60:61], v[44:45], v[42:43] op_sel_hi:[0,1,1] neg_lo:[0,0,1] neg_hi:[0,0,1]
    v_cvt_pk_bf16_f32 v66, v40, v42
    v_cvt_pk_bf16_f32 v74, v41, v43
    v_cvt_pk_bf16_f32 v67, v44, v46
    v_cvt_pk_bf16_f32 v75, v45, v47
    v_xor_b32 v72, v72, v59
    v_xor_b32 v73, v73, v59
    v_xor_b32 v74, v74, v59
    v_xor_b32 v75, v75, v59
    v_xor_b32 v68, v64, v63
    v_xor_b32 v76, v72, v63
    v_xor_b32 v69, v65, v63
    v_xor_b32 v77, v73, v63
    v_xor_b32 v70, v66, v63
    v_xor_b32 v78, v74, v63
    v_xor_b32 v71, v67, v63
    v_xor_b32 v79, v75, v63
    s_waitcnt lgkmcnt(0)
    s_and_b32 s29, s44, 31
    s_sub_u32 s30, 2048, s44
    s_and_b32 s30, s30, 31
    s_cmp_eq_u32 s29, s24
    s_cbranch_scc1 k2p_own
    s_cmp_eq_u32 s30, s24
    s_cbranch_scc1 k2p_own
    s_cmp_eq_u32 s25, 0
    s_cbranch_scc1 k2pn_w5
    s_waitcnt vmcnt(4)
    s_branch k2pn_w
k2pn_w5:
    s_waitcnt vmcnt(5)
k2pn_w:
    ds_write_b64 v4, v[8:9]
    ds_write_b64 v4, v[10:11] offset:2048
    ds_write_b64 v4, v[12:13] offset:1024
    ds_write_b64 v4, v[14:15] offset:3072
    s_waitcnt lgkmcnt(0)
    s_barrier
    v_lshlrev_b32 v4, 3, v5
    ds_read_b64_tr_b16 v[80:81], v4 offset:0
    ds_read_b64_tr_b16 v[82:83], v4 offset:512
    ds_read_b64_tr_b16 v[88:89], v4 offset:2048
    ds_read_b64_tr_b16 v[90:91], v4 offset:2560
    ds_read_b64_tr_b16 v[96:97], v4 offset:4224
    ds_read_b64_tr_b16 v[98:99], v4 offset:4736
    ds_read_b64_tr_b16 v[104:105], v4 offset:6272
    ds_read_b64_tr_b16 v[106:107], v4 offset:6784
    ds_read_b64_tr_b16 v[84:85], v4 offset:1024
    ds_read_b64_tr_b16 v[86:87], v4 offset:1536
    ds_read_b64_tr_b16 v[92:93], v4 offset:3072
    ds_read_b64_tr_b16 v[94:95], v4 offset:3584
    ds_read_b64_tr_b16 v[100:101], v4 offset:5248
    ds_read_b64_tr_b16 v[102:103], v4 offset:5760
    ds_read_b64_tr_b16 v[108:109], v4 offset:7296
    ds_read_b64_tr_b16 v[110:111], v4 offset:7808
    s_waitcnt lgkmcnt(8)
    v_mfma_f32_16x16x32_bf16 v[112:115], v[80:83], v[64:67], 0
    v_mfma_f32_16x16x32_bf16 v[116:119], v[96:99], v[64:67], 0
    v_mfma_f32_16x16x32_bf16 v[112:115], v[88:91], v[72:75], v[112:115]
    v_mfma_f32_16x16x32_bf16 v[116:119], v[104:107], v[72:75], v[116:119]
    s_waitcnt lgkmcnt(0)
    v_mfma_f32_16x16x32_bf16 v[112:115], v[84:87], v[68:71], v[112:115]
    v_mfma_f32_16x16x32_bf16 v[116:119], v[100:103], v[68:71], v[116:119]
    v_mfma_f32_16x16x32_bf16 v[112:115], v[92:95], v[76:79], v[112:115]
    v_mfma_f32_16x16x32_bf16 v[116:119], v[108:111], v[76:79], v[116:119]
    s_nop 6
    ds_bpermute_b32 v80, v120, v112
    ds_bpermute_b32 v81, v120, v113
    ds_bpermute_b32 v82, v120, v114
    ds_bpermute_b32 v83, v120, v115
    ds_bpermute_b32 v84, v120, v116
    ds_bpermute_b32 v85, v120, v117
    ds_bpermute_b32 v86, v120, v118
    ds_bpermute_b32 v87, v120, v119
    s_waitcnt vmcnt(0)
    v_mul_f32 v32, v32, v33
    v_add_f32 v33, 1.0, v33
    v_mul_f32 v34, v34, v35
    v_add_f32 v35, 1.0, v35
    s_waitcnt lgkmcnt(0)
    v_pk_add_f32 v[40:41], v[80:81], v[32:33] op_sel_hi:[1,0] neg_lo:[0,1] neg_hi:[0,1]
    v_pk_add_f32 v[48:49], v[80:81], v[34:35] op_sel_hi:[1,0] neg_lo:[0,1] neg_hi:[0,1]
    v_pk_add_f32 v[42:43], v[82:83], v[32:33] op_sel_hi:[1,0] neg_lo:[0,1] neg_hi:[0,1]
    v_pk_add_f32 v[50:51], v[82:83], v[34:35] op_sel_hi:[1,0] neg_lo:[0,1] neg_hi:[0,1]
    v_pk_add_f32 v[44:45], v[84:85], v[32:33] op_sel_hi:[1,0] neg_lo:[0,1] neg_hi:[0,1]
    v_pk_add_f32 v[52:53], v[84:85], v[34:35] op_sel_hi:[1,0] neg_lo:[0,1] neg_hi:[0,1]
    v_pk_add_f32 v[46:47], v[86:87], v[32:33] op_sel_hi:[1,0] neg_lo:[0,1] neg_hi:[0,1]
    v_pk_add_f32 v[54:55], v[86:87], v[34:35] op_sel_hi:[1,0] neg_lo:[0,1] neg_hi:[0,1]
    v_lshlrev_b32 v56, 16, v24
    v_and_b32 v57, 0xffff0000, v24
    v_fma_f32 v56, v56, v33, v40
    v_fma_f32 v57, v57, v33, v44
    v_cvt_pk_bf16_f32 v64, v56, v57
    v_lshlrev_b32 v56, 16, v25
    v_and_b32 v57, 0xffff0000, v25
    v_fma_f32 v56, v56, v33, v41
    v_fma_f32 v57, v57, v33, v45
    v_cvt_pk_bf16_f32 v65, v56, v57
    v_lshlrev_b32 v56, 16, v26
    v_and_b32 v57, 0xffff0000, v26
    v_fma_f32 v56, v56, v33, v42
    v_fma_f32 v57, v57, v33, v46
    v_cvt_pk_bf16_f32 v66, v56, v57
    v_lshlrev_b32 v56, 16, v27
    v_and_b32 v57, 0xffff0000, v27
    v_fma_f32 v56, v56, v33, v43
    v_fma_f32 v57, v57, v33, v47
    v_cvt_pk_bf16_f32 v67, v56, v57
    v_lshlrev_b32 v58, 16, v28
    v_and_b32 v59, 0xffff0000, v28
    v_fma_f32 v58, v58, v35, v55
    v_fma_f32 v59, v59, v35, v51
    v_cvt_pk_bf16_f32 v68, v58, v59
    v_lshlrev_b32 v58, 16, v29
    v_and_b32 v59, 0xffff0000, v29
    v_fma_f32 v58, v58, v35, v54
    v_fma_f32 v59, v59, v35, v50
    v_cvt_pk_bf16_f32 v69, v58, v59
    v_lshlrev_b32 v58, 16, v30
    v_and_b32 v59, 0xffff0000, v30
    v_fma_f32 v58, v58, v35, v53
    v_fma_f32 v59, v59, v35, v49
    v_cvt_pk_bf16_f32 v70, v58, v59
    v_lshlrev_b32 v58, 16, v31
    v_and_b32 v59, 0xffff0000, v31
    v_fma_f32 v58, v58, v35, v52
    v_fma_f32 v59, v59, v35, v48
    v_cvt_pk_bf16_f32 v71, v58, v59
    buffer_store_dwordx4 v[64:67], v20, s[16:19], 0 offen
    buffer_store_dwordx4 v[68:71], v21, s[16:19], 0 offen
    s_cmp_eq_u32 s25, 0
    s_cbranch_scc0 k2pn_done
    v_lshlrev_b32 v37, 16, v37
    v_fma_f32 v37, v37, v33, -v32
    v_cvt_pk_bf16_f32 v37, v37, v37
    s_mov_b32 exec_lo, 0x11111111
    s_mov_b32 exec_hi, 0x11111111
    buffer_store_short v37, v36, s[16:19], 0 offen
k2pn_done:
    s_branch k2p_end
k2p_own:
    s_add_u32 s48, s8, 2424832
    s_addc_u32 s49, s9, 0
    s_mov_b32 s50, 368640
    s_mov_b32 s51, 0x00020000
    v_lshrrev_b32 v128, 3, v0
    v_mul_u32_u24 v128, 2560, v128
    v_and_b32 v129, 7, v0
    v_lshlrev_b32 v129, 4, v129
    v_add_u32 v128, v128, v129
    s_mov_b32 s56, s48
    s_mov_b32 s57, s49
    s_mov_b32 s59, 0x00020000
    s_and_b32 s29, s44, 31
    s_cmp_eq_u32 s29, s24
    s_cselect_b32 s50, 368640, 0
    s_sub_u32 s30, 2048, s44
    s_and_b32 s30, s30, 31
    s_cmp_eq_u32 s30, s24
    s_cselect_b32 s58, 368640, 0
    s_lshl_b32 s29, s25, 7
    s_sub_u32 s30, 2432, s29
    s_add_u32 s29, s29, 128
    buffer_load_dwordx4 v[132:135], v128, s[48:51], s29 offen
    buffer_load_dwordx4 v[152:155], v128, s[56:59], s30 offen
    s_add_u32 s29, s29, 81920
    s_add_u32 s30, s30, 81920
    buffer_load_dwordx4 v[136:139], v128, s[48:51], s29 offen
    buffer_load_dwordx4 v[156:159], v128, s[56:59], s30 offen
    s_add_u32 s29, s29, 81920
    s_add_u32 s30, s30, 81920
    buffer_load_dwordx4 v[140:143], v128, s[48:51], s29 offen
    buffer_load_dwordx4 v[160:163], v128, s[56:59], s30 offen
    s_add_u32 s29, s29, 81920
    s_add_u32 s30, s30, 81920
    buffer_load_dwordx4 v[144:147], v128, s[48:51], s29 offen
    buffer_load_dwordx4 v[164:167], v128, s[56:59], s30 offen
    s_add_u32 s29, s29, 81920
    s_add_u32 s30, s30, 81920
    buffer_load_dwordx4 v[148:151], v128, s[48:51], s29 offen
    buffer_load_dwordx4 v[168:171], v128, s[56:59], s30 offen
    v_mov_b32 v172, 0
    s_mul_i32 s29, s26, 92160
    s_add_u32 s29, s29, 124
    v_mul_u32_u24 v130, 2560, v5
    s_cmp_eq_u32 s25, 0
    s_cselect_b32 s30, 36, 0
    v_cmp_gt_u32 vcc, s30, v5
    s_and_saveexec_b64 s[52:53], vcc
    buffer_load_dword v172, v130, s[48:51], s29 offen
    s_mov_b64 exec, s[52:53]
    v_lshlrev_b32 v131, 2, v0
    v_mov_b32 v173, 0
    v_cmp_gt_u32 vcc, 80, v0
    s_and_saveexec_b64 s[52:53], vcc
    ds_write_b32 v131, v173 offset:8448
    s_mov_b64 exec, s[52:53]
    s_cmp_eq_u32 s25, 0
    s_cbranch_scc1 k2po_w5
    s_waitcnt vmcnt(15)
    s_branch k2po_w
k2po_w5:
    s_waitcnt vmcnt(16)
k2po_w:
    ds_write_b64 v4, v[8:9]
    ds_write_b64 v4, v[10:11] offset:2048
    ds_write_b64 v4, v[12:13] offset:1024
    ds_write_b64 v4, v[14:15] offset:3072
    s_waitcnt lgkmcnt(0)
    s_barrier
    v_lshlrev_b32 v4, 3, v5
    ds_read_b64_tr_b16 v[80:81], v4 offset:0
    ds_read_b64_tr_b16 v[82:83], v4 offset:512
    ds_read_b64_tr_b16 v[88:89], v4 offset:2048
    ds_read_b64_tr_b16 v[90:91], v4 offset:2560
    ds_read_b64_tr_b16 v[96:97], v4 offset:4224
    ds_read_b64_tr_b16 v[98:99], v4 offset:4736
    ds_read_b64_tr_b16 v[104:105], v4 offset:6272
    ds_read_b64_tr_b16 v[106:107], v4 offset:6784
    ds_read_b64_tr_b16 v[84:85], v4 offset:1024
    ds_read_b64_tr_b16 v[86:87], v4 offset:1536
    ds_read_b64_tr_b16 v[92:93], v4 offset:3072
    ds_read_b64_tr_b16 v[94:95], v4 offset:3584
    ds_read_b64_tr_b16 v[100:101], v4 offset:5248
    ds_read_b64_tr_b16 v[102:103], v4 offset:5760
    ds_read_b64_tr_b16 v[108:109], v4 offset:7296
    ds_read_b64_tr_b16 v[110:111], v4 offset:7808
    s_waitcnt lgkmcnt(8)
    v_mfma_f32_16x16x32_bf16 v[112:115], v[80:83], v[64:67], 0
    v_mfma_f32_16x16x32_bf16 v[116:119], v[96:99], v[64:67], 0
    v_mfma_f32_16x16x32_bf16 v[112:115], v[88:91], v[72:75], v[112:115]
    v_mfma_f32_16x16x32_bf16 v[116:119], v[104:107], v[72:75], v[116:119]
    s_waitcnt lgkmcnt(0)
    v_mfma_f32_16x16x32_bf16 v[112:115], v[84:87], v[68:71], v[112:115]
    v_mfma_f32_16x16x32_bf16 v[116:119], v[100:103], v[68:71], v[116:119]
    v_mfma_f32_16x16x32_bf16 v[112:115], v[92:95], v[76:79], v[112:115]
    v_mfma_f32_16x16x32_bf16 v[116:119], v[108:111], v[76:79], v[116:119]
    s_nop 6
    ds_bpermute_b32 v80, v120, v112
    ds_bpermute_b32 v81, v120, v113
    ds_bpermute_b32 v82, v120, v114
    ds_bpermute_b32 v83, v120, v115
    ds_bpermute_b32 v84, v120, v116
    ds_bpermute_b32 v85, v120, v117
    ds_bpermute_b32 v86, v120, v118
    ds_bpermute_b32 v87, v120, v119
    v_mov_b32 v173, s45
    v_mul_f32 v173, 0xbfb8aa3b, v173
    v_exp_f32 v173, v173
    v_lshlrev_b32 v131, 5, v17
    v_sub_u32 v130, 96, v131
    v_mov_b32 v129, 0
    v_add_f32 v173, 1.0, v173
    v_rcp_f32 v173, v173
    v_and_b32 v121, 7, v5
    v_lshlrev_b32 v121, 4, v121
    v_bfe_u32 v122, v5, 4, 1
    v_lshl_add_u32 v121, v122, 7, v121
    v_lshrrev_b32 v122, 5, v5
    v_lshl_add_u32 v121, v122, 2, v121
    v_cmp_eq_u32 vcc, s44, v18
    s_nop 1
    v_cndmask_b32 v174, 0, v173, vcc
    v_cmp_eq_u32 vcc, s44, v19
    s_nop 1
    v_cndmask_b32 v175, 0, v173, vcc
    s_waitcnt vmcnt(0) lgkmcnt(0)
    v_pk_add_f32 v[132:133], v[132:133], v[136:137]
    v_pk_add_f32 v[152:153], v[152:153], v[156:157]
    v_pk_add_f32 v[134:135], v[134:135], v[138:139]
    v_pk_add_f32 v[154:155], v[154:155], v[158:159]
    v_pk_add_f32 v[132:133], v[132:133], v[140:141]
    v_pk_add_f32 v[152:153], v[152:153], v[160:161]
    v_pk_add_f32 v[134:135], v[134:135], v[142:143]
    v_pk_add_f32 v[154:155], v[154:155], v[162:163]
    v_pk_add_f32 v[132:133], v[132:133], v[144:145]
    v_pk_add_f32 v[152:153], v[152:153], v[164:165]
    v_pk_add_f32 v[134:135], v[134:135], v[146:147]
    v_pk_add_f32 v[154:155], v[154:155], v[166:167]
    v_pk_add_f32 v[132:133], v[132:133], v[148:149]
    v_pk_add_f32 v[152:153], v[152:153], v[168:169]
    v_pk_add_f32 v[134:135], v[134:135], v[150:151]
    v_pk_add_f32 v[154:155], v[154:155], v[170:171]
    v_add_f32 v132, v132, v132 row_ror:8 row_mask:0xf bank_mask:0xf
    v_add_f32 v133, v133, v133 row_ror:8 row_mask:0xf bank_mask:0xf
    v_add_f32 v134, v134, v134 row_ror:8 row_mask:0xf bank_mask:0xf
    v_add_f32 v135, v135, v135 row_ror:8 row_mask:0xf bank_mask:0xf
    v_add_f32 v152, v152, v152 row_ror:8 row_mask:0xf bank_mask:0xf
    v_add_f32 v153, v153, v153 row_ror:8 row_mask:0xf bank_mask:0xf
    v_add_f32 v154, v154, v154 row_ror:8 row_mask:0xf bank_mask:0xf
    v_add_f32 v155, v155, v155 row_ror:8 row_mask:0xf bank_mask:0xf
    v_permlane16_swap_b32 v132, v152
    v_permlane16_swap_b32 v133, v153
    v_permlane16_swap_b32 v134, v154
    v_permlane16_swap_b32 v135, v155
    v_add_f32 v132, v132, v152
    v_add_f32 v133, v133, v153
    v_add_f32 v134, v134, v154
    v_add_f32 v135, v135, v155
    v_permlane32_swap_b32 v132, v133
    s_nop 0
    v_permlane32_swap_b32 v134, v135
    v_add_f32 v132, v132, v133
    v_add_f32 v134, v134, v135
    s_mov_b32 exec_lo, 0x00ff00ff
    s_mov_b32 exec_hi, 0x00ff00ff
    ds_add_f32 v121, v132 offset:8448
    ds_add_f32 v121, v134 offset:8456
    s_mov_b64 exec, -1
    s_cmp_eq_u32 s25, 0
    s_cbranch_scc0 k2po_nz
    ds_add_f32 v129, v172 offset:8704
k2po_nz:
    v_mul_f32 v32, v32, v33
    v_add_f32 v33, 1.0, v33
    v_mul_f32 v34, v34, v35
    v_add_f32 v35, 1.0, v35
    v_pk_add_f32 v[40:41], v[80:81], v[32:33] op_sel_hi:[1,0] neg_lo:[0,1] neg_hi:[0,1]
    v_pk_add_f32 v[48:49], v[80:81], v[34:35] op_sel_hi:[1,0] neg_lo:[0,1] neg_hi:[0,1]
    v_pk_add_f32 v[42:43], v[82:83], v[32:33] op_sel_hi:[1,0] neg_lo:[0,1] neg_hi:[0,1]
    v_pk_add_f32 v[50:51], v[82:83], v[34:35] op_sel_hi:[1,0] neg_lo:[0,1] neg_hi:[0,1]
    v_pk_add_f32 v[44:45], v[84:85], v[32:33] op_sel_hi:[1,0] neg_lo:[0,1] neg_hi:[0,1]
    v_pk_add_f32 v[52:53], v[84:85], v[34:35] op_sel_hi:[1,0] neg_lo:[0,1] neg_hi:[0,1]
    v_pk_add_f32 v[46:47], v[86:87], v[32:33] op_sel_hi:[1,0] neg_lo:[0,1] neg_hi:[0,1]
    v_pk_add_f32 v[54:55], v[86:87], v[34:35] op_sel_hi:[1,0] neg_lo:[0,1] neg_hi:[0,1]
    v_lshlrev_b32 v56, 16, v24
    v_and_b32 v57, 0xffff0000, v24
    v_lshlrev_b32 v58, 16, v28
    v_and_b32 v59, 0xffff0000, v28
    v_fmac_f32 v40, v56, v33
    v_fmac_f32 v44, v57, v33
    v_fmac_f32 v55, v58, v35
    v_fmac_f32 v51, v59, v35
    v_lshlrev_b32 v56, 16, v25
    v_and_b32 v57, 0xffff0000, v25
    v_lshlrev_b32 v58, 16, v29
    v_and_b32 v59, 0xffff0000, v29
    v_fmac_f32 v41, v56, v33
    v_fmac_f32 v45, v57, v33
    v_fmac_f32 v54, v58, v35
    v_fmac_f32 v50, v59, v35
    v_lshlrev_b32 v56, 16, v26
    v_and_b32 v57, 0xffff0000, v26
    v_lshlrev_b32 v58, 16, v30
    v_and_b32 v59, 0xffff0000, v30
    v_fmac_f32 v42, v56, v33
    v_fmac_f32 v46, v57, v33
    v_fmac_f32 v53, v58, v35
    v_fmac_f32 v49, v59, v35
    v_lshlrev_b32 v56, 16, v27
    v_and_b32 v57, 0xffff0000, v27
    v_lshlrev_b32 v58, 16, v31
    v_and_b32 v59, 0xffff0000, v31
    v_fmac_f32 v43, v56, v33
    v_fmac_f32 v47, v57, v33
    v_fmac_f32 v52, v58, v35
    v_fmac_f32 v48, v59, v35
    s_waitcnt lgkmcnt(0)
    s_barrier
    ds_read_b128 v[132:135], v131 offset:8448
    ds_read_b128 v[136:139], v131 offset:8464
    ds_read_b128 v[152:155], v130 offset:8576
    ds_read_b128 v[156:159], v130 offset:8592
    ds_read_b32 v172, v129 offset:8704
    s_waitcnt lgkmcnt(4)
    v_fmac_f32 v40, v132, v174
    v_fmac_f32 v44, v133, v174
    v_fmac_f32 v41, v134, v174
    v_fmac_f32 v45, v135, v174
    s_waitcnt lgkmcnt(3)
    v_fmac_f32 v42, v136, v174
    v_fmac_f32 v46, v137, v174
    v_fmac_f32 v43, v138, v174
    v_fmac_f32 v47, v139, v174
    s_waitcnt lgkmcnt(0)
    v_fmac_f32 v55, v152, v175
    v_fmac_f32 v51, v153, v175
    v_fmac_f32 v54, v154, v175
    v_fmac_f32 v50, v155, v175
    v_fmac_f32 v53, v156, v175
    v_fmac_f32 v49, v157, v175
    v_fmac_f32 v52, v158, v175
    v_fmac_f32 v48, v159, v175
    v_cvt_pk_bf16_f32 v64, v40, v44
    v_cvt_pk_bf16_f32 v65, v41, v45
    v_cvt_pk_bf16_f32 v66, v42, v46
    v_cvt_pk_bf16_f32 v67, v43, v47
    v_cvt_pk_bf16_f32 v68, v55, v51
    v_cvt_pk_bf16_f32 v69, v54, v50
    v_cvt_pk_bf16_f32 v70, v53, v49
    v_cvt_pk_bf16_f32 v71, v52, v48
    buffer_store_dwordx4 v[64:67], v20, s[16:19], 0 offen
    buffer_store_dwordx4 v[68:71], v21, s[16:19], 0 offen
    s_cmp_eq_u32 s25, 0
    s_cbranch_scc0 k2po_done
    v_lshlrev_b32 v37, 16, v37
    v_fma_f32 v37, v37, v33, -v32
    v_fmac_f32 v37, v172, v174
    v_cvt_pk_bf16_f32 v37, v37, v37
    s_mov_b32 exec_lo, 0x11111111
    s_mov_b32 exec_hi, 0x11111111
    buffer_store_short v37, v36, s[16:19], 0 offen
k2po_done:
k2p_end:
k2_end:
    s_endpgm
.section .rodata,"a"
.p2align 6
.amdhsa_kernel k1_kernel
  .amdhsa_next_free_vgpr 256
  .amdhsa_next_free_sgpr 102
  .amdhsa_accum_offset 256
  .amdhsa_group_segment_fixed_size 0
  .amdhsa_kernarg_size 104
  .amdhsa_user_sgpr_count 2
  .amdhsa_user_sgpr_kernarg_segment_ptr 1
  .amdhsa_system_sgpr_workgroup_id_x 1
.end_amdhsa_kernel
.p2align 6
.amdhsa_kernel k2_kernel
  .amdhsa_next_free_vgpr 176
  .amdhsa_next_free_sgpr 102
  .amdhsa_accum_offset 176
  .amdhsa_group_segment_fixed_size 0
  .amdhsa_kernarg_size 104
  .amdhsa_user_sgpr_count 2
  .amdhsa_user_sgpr_kernarg_segment_ptr 1
  .amdhsa_system_sgpr_workgroup_id_x 1
.end_amdhsa_kernel
```
